```python
import torch

def _softmax(x, axis=-1):
    return torch.softmax(x, dim=axis)
def _gelu(x):
    return torch.nn.functional.gelu(x, approximate="tanh")
def _silu(x):
    return torch.nn.functional.silu(x)
def _sigmoid(x):
    return torch.sigmoid(x)
def _layernorm(x, axis=-1, eps=1e-5):
    m = x.mean(dim=axis, keepdim=True)
    v = x.var(dim=axis, keepdim=True, unbiased=False)
    return (x - m) / torch.sqrt(v + eps)
def _scatter_add(tgt, idx, src, axis=0):
    return tgt.clone().index_add_(axis, idx, src)
def _segment_sum(src, seg, n):
    out = torch.zeros((n,) + src.shape[1:], dtype=src.dtype)
    return out.index_add_(0, seg, src)
def _pad(x, pw):
    flat = tuple(v for pair in reversed(pw) for v in pair)
    return torch.nn.functional.pad(x, flat)

kernel_name = 'standalone__linear_kernel_rfa__sampling'

def setup_inputs():

    _w = (lambda a: (lambda t: t.to(torch.bfloat16) if t.is_floating_point() else t)(torch.as_tensor(a)))
    B, H, Sq, Sk, D, M = 16, 32, 8, 2048, 128, 16
    return {
        "q": _w((lambda *s: torch.randn(*s, dtype=torch.bfloat16) * 0.2)(B, H, Sq, D)),
        "k": _w((lambda *s: torch.randn(*s, dtype=torch.bfloat16) * 1.6)(B, H, Sk, D)),
        "v": _w((lambda *s: torch.randn(*s, dtype=torch.bfloat16) * 1.6)(B, H, Sk, D)),
        "omega": _w((lambda *s: torch.randn(*s, dtype=torch.bfloat16) * 1.6)(M, D)),
    }

def reference(q, k, v, omega):
    d = q.shape[-1]
    m = omega.shape[0]
    scale = float(d) ** -0.25
    qs = q * scale
    ks = k * scale
    q_proj = torch.einsum("bhsd,md->bhsm", qs, omega)
    k_proj = torch.einsum("bhsd,md->bhsm", ks, omega)
    q_sq = 0.5 * torch.einsum("bhsd,bhsd->bhs", qs, qs)[..., None]
    k_sq = 0.5 * torch.einsum("bhsd,bhsd->bhs", ks, ks)[..., None]
    inv_sqrt_m = float(m) ** -0.5
    phi_q = torch.exp(q_proj - q_sq) * inv_sqrt_m + 1e-6
    phi_k = torch.exp(k_proj - k_sq) * inv_sqrt_m + 1e-6
    kv = torch.einsum("bhsm,bhsd->bhmd", phi_k, v)
    z  = torch.einsum("bhsm->bhm", phi_k)
    num = torch.einsum("bhqm,bhmd->bhqd", phi_q, kv)
    den = torch.einsum("bhqm,bhm->bhq", phi_q, z)[..., None] + 1e-6
    return num / den
```

```asm
; @launch grid=(256,1,1) block=(384,1,1) lds=163328
.amdgcn_target "amdgcn-amd-amdhsa--gfx950"
.text
.globl standalone__linear_kernel_rfa__sampling_kernel
.p2align 8
.type standalone__linear_kernel_rfa__sampling_kernel,@function
standalone__linear_kernel_rfa__sampling_kernel:
    s_cmp_ge_u32 s2, 256
    s_cbranch_scc1 L_done
    s_load_dwordx8 s[32:39], s[0:1], 0
    s_load_dwordx4 s[40:43], s[0:1], 32
    s_load_dwordx2 s[46:47], s[0:1], 48
    v_readfirstlane_b32 s25, v0
    v_and_b32 v0, 63, v0
    v_and_b32 v1, 15, v0
    v_lshrrev_b32 v2, 4, v0
    s_lshr_b32 s25, s25, 6
    s_mov_b32 s60, s2
    s_lshr_b32 s62, s60, 0
    s_lshl_b32 s62, s62, 1
    s_and_b32 s63, s60, 0
    s_or_b32 s62, s62, s63
    s_lshl_b32 s63, s62, 11
    s_lshl_b32 s62, s62, 19
    s_mov_b32 s59, 0x200000
    s_cmp_eq_u32 s25, 5
    s_cbranch_scc1 L_ctl
    s_cmp_lg_u32 s25, 0
    s_cbranch_scc1 L_consumer
    s_setprio 3
    v_and_b32 v22, 1, v2
    v_lshlrev_b32 v22, 13, v22
    v_lshrrev_b32 v3, 1, v2
    v_lshl_or_b32 v22, v3, 8, v22
    v_xor_b32 v3, v1, v2
    v_xor_b32 v23, 0, v3
    v_lshl_add_u32 v4, v23, 4, v22
    v_xor_b32 v23, 4, v3
    v_lshl_add_u32 v5, v23, 4, v22
    v_xor_b32 v23, 8, v3
    v_lshl_add_u32 v6, v23, 4, v22
    v_xor_b32 v23, 12, v3
    v_lshl_add_u32 v7, v23, 4, v22
    v_lshlrev_b32 v23, 1, v2
    v_xor_b32 v3, v1, v23
    v_xor_b32 v23, 0, v3
    v_lshl_add_u32 v8, v23, 4, v22
    v_xor_b32 v23, 8, v3
    v_lshl_add_u32 v9, v23, 4, v22
    v_lshlrev_b32 v12, 2, v0
    v_add_u32 v12, 159744, v12
    v_mov_b32 v13, 0
    ds_write_b32 v12, v13 offset:256
    ds_write_b32 v12, v13 offset:512
    ds_write_b32 v12, v13 offset:768
    ds_write_b32 v12, v13 offset:1024
    ds_write_b32 v12, v13 offset:1280
    ds_write_b32 v12, v13 offset:1536
    ds_write_b32 v12, v13 offset:1792
    ds_write_b32 v12, v13 offset:2048
    v_mov_b32 v14, 0x80000000
    ds_write_b32 v12, v14
    v_mov_b32 v14, 20
    ds_write_b32 v12, v14 offset:2304
    v_and_b32 v15, 3, v0
    v_lshlrev_b32 v15, 8, v15
    v_add_u32 v15, 160000, v15
    v_mov_b32 v14, 162048
    v_cmp_eq_u32 vcc, 4, v0
    v_cndmask_b32 v15, v15, v14, vcc
    ds_read_b32 v16, v15
    s_waitcnt lgkmcnt(0)
    s_barrier
    s_add_u32 s4, s34, s62
    s_addc_u32 s5, s35, 0
    s_and_b32 s5, s5, 0xffff
    s_mov_b32 s6, 1048576
    s_mov_b32 s7, 0x20000
    s_add_u32 s8, s36, s62
    s_addc_u32 s9, s37, 0
    s_and_b32 s9, s9, 0xffff
    s_mov_b32 s10, 1048576
    s_mov_b32 s11, 0x20000
    s_mov_b32 s20, 0
    s_mov_b32 s19, 0
    s_and_b32 s19, s19, 15
    s_mov_b32 s20, 0
    s_add_u32 s21, s20, s19
    s_and_b32 s21, s21, 15
    s_and_b32 s27, s20, 16
    s_lshl_b32 s29, s27, 15
    s_bfe_u32 s27, s21, 65536
    s_lshl_b32 s27, s27, 18
    s_or_b32 s29, s29, s27
    s_bfe_u32 s27, s21, 65537
    s_lshl_b32 s27, s27, 17
    s_or_b32 s29, s29, s27
    s_bfe_u32 s27, s21, 65538
    s_lshl_b32 s27, s27, 12
    s_or_b32 s29, s29, s27
    s_bfe_u32 s27, s21, 65539
    s_lshl_b32 s27, s27, 14
    s_or_b32 s29, s29, s27
    s_mov_b32 s21, s29
    s_mov_b32 s22, 0x80000000
.p2align 6
L_ld:
    s_and_b32 s26, s20, 1
    s_lshl_b32 s26, s26, 14
    s_add_i32 s28, s20, -1
L_ld_chk:
    s_waitcnt lgkmcnt(0)
    v_cmp_gt_i32 vcc, s28, v16
    v_readlane_b32 s31, v16, 4
    s_lshl_b32 s24, s20, 1
    s_nop 1
    s_and_b32 s27, vcc_lo, 15
    s_cbranch_scc0 L_ld_go
    s_sub_u32 s59, s59, 1
    s_cbranch_scc1 L_done
    ds_read_b32 v16, v15
    s_branch L_ld_chk
L_ld_go:
    s_cmp_le_u32 s31, 20
    s_cbranch_scc1 L_var20
    s_cmp_le_u32 s31, 21
    s_cbranch_scc1 L_var21
    s_cmp_le_u32 s31, 22
    s_cbranch_scc1 L_var22
    s_cmp_le_u32 s31, 23
    s_cbranch_scc1 L_var23
    s_cmp_le_u32 s31, 24
    s_cbranch_scc1 L_var24
    s_cmp_le_u32 s31, 25
    s_cbranch_scc1 L_var25
L_var26:
    s_add_u32 m0, s26, 0
    s_add_u32 s30, s21, 0
    s_waitcnt vmcnt(25)
    buffer_load_dwordx4 v4, s[4:7], s30 offen nt lds
    s_add_u32 m0, s26, 1024
    s_add_u32 s30, s21, 512
    s_waitcnt vmcnt(25)
    buffer_load_dwordx4 v5, s[4:7], s30 offen nt lds
    s_add_u32 m0, s26, 2048
    s_add_u32 s30, s21, 1024
    s_waitcnt vmcnt(25)
    buffer_load_dwordx4 v6, s[4:7], s30 offen nt lds
    s_add_u32 m0, s26, 3072
    s_add_u32 s30, s21, 1536
    s_waitcnt vmcnt(25)
    buffer_load_dwordx4 v7, s[4:7], s30 offen nt lds
    s_add_u32 m0, s26, 4096
    s_add_u32 s30, s21, 65536
    s_waitcnt vmcnt(25)
    buffer_load_dwordx4 v4, s[4:7], s30 offen nt lds
    s_add_u32 m0, s26, 5120
    s_add_u32 s30, s21, 66048
    s_waitcnt vmcnt(25)
    buffer_load_dwordx4 v5, s[4:7], s30 offen nt lds
    s_add_u32 m0, s26, 6144
    s_add_u32 s30, s21, 66560
    s_waitcnt vmcnt(25)
    buffer_load_dwordx4 v6, s[4:7], s30 offen nt lds
    s_add_u32 m0, s26, 7168
    s_add_u32 s30, s21, 67072
    s_waitcnt vmcnt(25)
    buffer_load_dwordx4 v7, s[4:7], s30 offen nt lds
    s_add_u32 m0, s26, 32768
    s_add_u32 s30, s21, 2048
    s_waitcnt vmcnt(25)
    buffer_load_dwordx4 v4, s[4:7], s30 offen nt lds
    s_add_u32 m0, s26, 33792
    s_add_u32 s30, s21, 2560
    s_waitcnt vmcnt(25)
    buffer_load_dwordx4 v5, s[4:7], s30 offen nt lds
    s_add_u32 m0, s26, 34816
    s_add_u32 s30, s21, 3072
    s_waitcnt vmcnt(25)
    buffer_load_dwordx4 v6, s[4:7], s30 offen nt lds
    s_add_u32 m0, s26, 35840
    s_add_u32 s30, s21, 3584
    s_waitcnt vmcnt(25)
    buffer_load_dwordx4 v7, s[4:7], s30 offen nt lds
    s_add_u32 m0, s26, 36864
    s_add_u32 s30, s21, 67584
    s_waitcnt vmcnt(25)
    buffer_load_dwordx4 v4, s[4:7], s30 offen nt lds
    s_add_u32 m0, s26, 37888
    s_add_u32 s30, s21, 68096
    s_waitcnt vmcnt(25)
    buffer_load_dwordx4 v5, s[4:7], s30 offen nt lds
    s_add_u32 m0, s26, 38912
    s_add_u32 s30, s21, 68608
    s_waitcnt vmcnt(25)
    buffer_load_dwordx4 v6, s[4:7], s30 offen nt lds
    s_add_u32 m0, s26, 39936
    s_add_u32 s30, s21, 69120
    s_waitcnt vmcnt(25)
    buffer_load_dwordx4 v7, s[4:7], s30 offen nt lds
    s_add_u32 m0, s26, 65536
    s_add_u32 s30, s21, 32768
    s_waitcnt vmcnt(25)
    buffer_load_dwordx4 v4, s[4:7], s30 offen nt lds
    s_add_u32 m0, s26, 66560
    s_add_u32 s30, s21, 33280
    s_waitcnt vmcnt(25)
    buffer_load_dwordx4 v5, s[4:7], s30 offen nt lds
    s_add_u32 m0, s26, 67584
    s_add_u32 s30, s21, 33792
    s_waitcnt vmcnt(25)
    buffer_load_dwordx4 v6, s[4:7], s30 offen nt lds
    s_add_u32 m0, s26, 68608
    s_add_u32 s30, s21, 34304
    s_waitcnt vmcnt(25)
    buffer_load_dwordx4 v7, s[4:7], s30 offen nt lds
    s_add_u32 m0, s26, 69632
    s_add_u32 s30, s21, 98304
    s_waitcnt vmcnt(25)
    buffer_load_dwordx4 v4, s[4:7], s30 offen nt lds
    s_add_u32 m0, s26, 70656
    s_add_u32 s30, s21, 98816
    s_waitcnt vmcnt(25)
    buffer_load_dwordx4 v5, s[4:7], s30 offen nt lds
    s_add_u32 m0, s26, 71680
    s_add_u32 s30, s21, 99328
    s_waitcnt vmcnt(25)
    buffer_load_dwordx4 v6, s[4:7], s30 offen nt lds
    s_add_u32 m0, s26, 72704
    s_add_u32 s30, s21, 99840
    s_waitcnt vmcnt(25)
    buffer_load_dwordx4 v7, s[4:7], s30 offen nt lds
    s_add_u32 m0, s26, 98304
    s_add_u32 s30, s21, 34816
    s_waitcnt vmcnt(25)
    buffer_load_dwordx4 v4, s[4:7], s30 offen nt lds
    s_add_u32 m0, s26, 99328
    s_add_u32 s30, s21, 35328
    s_waitcnt vmcnt(25)
    s_add_i32 s27, s24, 0
    s_max_i32 s22, s22, s27
    v_mov_b32 v13, s22
    ds_write_b32 v12, v13
    buffer_load_dwordx4 v5, s[4:7], s30 offen nt lds
    s_add_u32 m0, s26, 100352
    s_add_u32 s30, s21, 35840
    s_waitcnt vmcnt(25)
    buffer_load_dwordx4 v6, s[4:7], s30 offen nt lds
    s_add_u32 m0, s26, 101376
    s_add_u32 s30, s21, 36352
    s_waitcnt vmcnt(25)
    buffer_load_dwordx4 v7, s[4:7], s30 offen nt lds
    s_add_u32 m0, s26, 102400
    s_add_u32 s30, s21, 100352
    s_waitcnt vmcnt(25)
    buffer_load_dwordx4 v4, s[4:7], s30 offen nt lds
    s_add_u32 m0, s26, 103424
    s_add_u32 s30, s21, 100864
    s_waitcnt vmcnt(25)
    buffer_load_dwordx4 v5, s[4:7], s30 offen nt lds
    s_add_u32 m0, s26, 104448
    s_add_u32 s30, s21, 101376
    s_waitcnt vmcnt(25)
    buffer_load_dwordx4 v6, s[4:7], s30 offen nt lds
    s_add_u32 m0, s26, 105472
    s_add_u32 s30, s21, 101888
    s_waitcnt vmcnt(25)
    buffer_load_dwordx4 v7, s[4:7], s30 offen nt lds
    s_add_u32 m0, s26, 8192
    s_add_u32 s30, s21, 0
    s_waitcnt vmcnt(25)
    buffer_load_dwordx4 v8, s[8:11], s30 offen nt lds
    s_add_u32 m0, s26, 9216
    s_add_u32 s30, s21, 512
    s_waitcnt vmcnt(25)
    buffer_load_dwordx4 v9, s[8:11], s30 offen nt lds
    s_add_u32 m0, s26, 10240
    s_add_u32 s30, s21, 1024
    s_waitcnt vmcnt(25)
    buffer_load_dwordx4 v8, s[8:11], s30 offen nt lds
    s_add_u32 m0, s26, 11264
    s_add_u32 s30, s21, 1536
    s_waitcnt vmcnt(25)
    buffer_load_dwordx4 v9, s[8:11], s30 offen nt lds
    s_add_u32 m0, s26, 12288
    s_add_u32 s30, s21, 65536
    s_waitcnt vmcnt(25)
    buffer_load_dwordx4 v8, s[8:11], s30 offen nt lds
    s_add_u32 m0, s26, 13312
    s_add_u32 s30, s21, 66048
    s_waitcnt vmcnt(25)
    buffer_load_dwordx4 v9, s[8:11], s30 offen nt lds
    s_add_u32 m0, s26, 14336
    s_add_u32 s30, s21, 66560
    s_waitcnt vmcnt(25)
    buffer_load_dwordx4 v8, s[8:11], s30 offen nt lds
    s_add_u32 m0, s26, 15360
    s_add_u32 s30, s21, 67072
    s_waitcnt vmcnt(25)
    buffer_load_dwordx4 v9, s[8:11], s30 offen nt lds
    s_add_u32 m0, s26, 40960
    s_add_u32 s30, s21, 2048
    s_waitcnt vmcnt(25)
    buffer_load_dwordx4 v8, s[8:11], s30 offen nt lds
    s_add_u32 m0, s26, 41984
    s_add_u32 s30, s21, 2560
    s_waitcnt vmcnt(25)
    buffer_load_dwordx4 v9, s[8:11], s30 offen nt lds
    s_add_u32 m0, s26, 43008
    s_add_u32 s30, s21, 3072
    s_waitcnt vmcnt(25)
    buffer_load_dwordx4 v8, s[8:11], s30 offen nt lds
    s_add_u32 m0, s26, 44032
    s_add_u32 s30, s21, 3584
    s_waitcnt vmcnt(25)
    buffer_load_dwordx4 v9, s[8:11], s30 offen nt lds
    s_add_u32 m0, s26, 45056
    s_add_u32 s30, s21, 67584
    s_waitcnt vmcnt(25)
    buffer_load_dwordx4 v8, s[8:11], s30 offen nt lds
    s_add_u32 m0, s26, 46080
    s_add_u32 s30, s21, 68096
    s_waitcnt vmcnt(25)
    buffer_load_dwordx4 v9, s[8:11], s30 offen nt lds
    s_add_u32 m0, s26, 47104
    s_add_u32 s30, s21, 68608
    s_waitcnt vmcnt(25)
    buffer_load_dwordx4 v8, s[8:11], s30 offen nt lds
    s_add_u32 m0, s26, 48128
    s_add_u32 s30, s21, 69120
    s_waitcnt vmcnt(25)
    buffer_load_dwordx4 v9, s[8:11], s30 offen nt lds
    s_add_u32 m0, s26, 73728
    s_add_u32 s30, s21, 32768
    s_waitcnt vmcnt(25)
    buffer_load_dwordx4 v8, s[8:11], s30 offen nt lds
    s_add_u32 m0, s26, 74752
    s_add_u32 s30, s21, 33280
    s_waitcnt vmcnt(25)
    buffer_load_dwordx4 v9, s[8:11], s30 offen nt lds
    s_add_u32 m0, s26, 75776
    s_add_u32 s30, s21, 33792
    s_waitcnt vmcnt(25)
    buffer_load_dwordx4 v8, s[8:11], s30 offen nt lds
    s_add_u32 m0, s26, 76800
    s_add_u32 s30, s21, 34304
    s_waitcnt vmcnt(25)
    buffer_load_dwordx4 v9, s[8:11], s30 offen nt lds
    s_add_u32 m0, s26, 77824
    s_add_u32 s30, s21, 98304
    s_waitcnt vmcnt(25)
    buffer_load_dwordx4 v8, s[8:11], s30 offen nt lds
    s_add_u32 m0, s26, 78848
    s_add_u32 s30, s21, 98816
    s_waitcnt vmcnt(25)
    buffer_load_dwordx4 v9, s[8:11], s30 offen nt lds
    s_add_u32 m0, s26, 79872
    s_add_u32 s30, s21, 99328
    s_waitcnt vmcnt(25)
    buffer_load_dwordx4 v8, s[8:11], s30 offen nt lds
    s_add_u32 m0, s26, 80896
    s_add_u32 s30, s21, 99840
    s_waitcnt vmcnt(25)
    buffer_load_dwordx4 v9, s[8:11], s30 offen nt lds
    s_add_u32 m0, s26, 106496
    s_add_u32 s30, s21, 34816
    s_waitcnt vmcnt(25)
    ds_read_b32 v16, v15
    buffer_load_dwordx4 v8, s[8:11], s30 offen nt lds
    s_add_u32 m0, s26, 107520
    s_add_u32 s30, s21, 35328
    s_waitcnt vmcnt(25)
    s_add_i32 s27, s24, 1
    s_max_i32 s22, s22, s27
    v_mov_b32 v13, s22
    ds_write_b32 v12, v13
    buffer_load_dwordx4 v9, s[8:11], s30 offen nt lds
    s_add_u32 m0, s26, 108544
    s_add_u32 s30, s21, 35840
    s_waitcnt vmcnt(25)
    buffer_load_dwordx4 v8, s[8:11], s30 offen nt lds
    s_add_u32 m0, s26, 109568
    s_add_u32 s30, s21, 36352
    s_waitcnt vmcnt(25)
    buffer_load_dwordx4 v9, s[8:11], s30 offen nt lds
    s_add_u32 m0, s26, 110592
    s_add_u32 s30, s21, 100352
    s_waitcnt vmcnt(25)
    buffer_load_dwordx4 v8, s[8:11], s30 offen nt lds
    s_add_u32 m0, s26, 111616
    s_add_u32 s30, s21, 100864
    s_waitcnt vmcnt(25)
    buffer_load_dwordx4 v9, s[8:11], s30 offen nt lds
    s_add_u32 m0, s26, 112640
    s_add_u32 s30, s21, 101376
    s_waitcnt vmcnt(25)
    buffer_load_dwordx4 v8, s[8:11], s30 offen nt lds
    s_add_u32 m0, s26, 113664
    s_add_u32 s30, s21, 101888
    s_waitcnt vmcnt(25)
    buffer_load_dwordx4 v9, s[8:11], s30 offen nt lds
    s_add_u32 s20, s20, 1
    s_add_u32 s21, s20, s19
    s_and_b32 s21, s21, 15
    s_and_b32 s27, s20, 16
    s_lshl_b32 s29, s27, 15
    s_bfe_u32 s27, s21, 65536
    s_lshl_b32 s27, s27, 18
    s_or_b32 s29, s29, s27
    s_bfe_u32 s27, s21, 65537
    s_lshl_b32 s27, s27, 17
    s_or_b32 s29, s29, s27
    s_bfe_u32 s27, s21, 65538
    s_lshl_b32 s27, s27, 12
    s_or_b32 s29, s29, s27
    s_bfe_u32 s27, s21, 65539
    s_lshl_b32 s27, s27, 14
    s_or_b32 s29, s29, s27
    s_mov_b32 s21, s29
    s_cmp_lt_u32 s20, 32
    s_cbranch_scc1 L_ld
    s_branch L_drain
L_var25:
    s_add_u32 m0, s26, 0
    s_add_u32 s30, s21, 0
    s_waitcnt vmcnt(24)
    buffer_load_dwordx4 v4, s[4:7], s30 offen nt lds
    s_add_u32 m0, s26, 1024
    s_add_u32 s30, s21, 512
    s_waitcnt vmcnt(24)
    buffer_load_dwordx4 v5, s[4:7], s30 offen nt lds
    s_add_u32 m0, s26, 2048
    s_add_u32 s30, s21, 1024
    s_waitcnt vmcnt(24)
    buffer_load_dwordx4 v6, s[4:7], s30 offen nt lds
    s_add_u32 m0, s26, 3072
    s_add_u32 s30, s21, 1536
    s_waitcnt vmcnt(24)
    buffer_load_dwordx4 v7, s[4:7], s30 offen nt lds
    s_add_u32 m0, s26, 4096
    s_add_u32 s30, s21, 65536
    s_waitcnt vmcnt(24)
    buffer_load_dwordx4 v4, s[4:7], s30 offen nt lds
    s_add_u32 m0, s26, 5120
    s_add_u32 s30, s21, 66048
    s_waitcnt vmcnt(24)
    buffer_load_dwordx4 v5, s[4:7], s30 offen nt lds
    s_add_u32 m0, s26, 6144
    s_add_u32 s30, s21, 66560
    s_waitcnt vmcnt(24)
    buffer_load_dwordx4 v6, s[4:7], s30 offen nt lds
    s_add_u32 m0, s26, 7168
    s_add_u32 s30, s21, 67072
    s_waitcnt vmcnt(24)
    buffer_load_dwordx4 v7, s[4:7], s30 offen nt lds
    s_add_u32 m0, s26, 32768
    s_add_u32 s30, s21, 2048
    s_waitcnt vmcnt(24)
    buffer_load_dwordx4 v4, s[4:7], s30 offen nt lds
    s_add_u32 m0, s26, 33792
    s_add_u32 s30, s21, 2560
    s_waitcnt vmcnt(24)
    buffer_load_dwordx4 v5, s[4:7], s30 offen nt lds
    s_add_u32 m0, s26, 34816
    s_add_u32 s30, s21, 3072
    s_waitcnt vmcnt(24)
    buffer_load_dwordx4 v6, s[4:7], s30 offen nt lds
    s_add_u32 m0, s26, 35840
    s_add_u32 s30, s21, 3584
    s_waitcnt vmcnt(24)
    buffer_load_dwordx4 v7, s[4:7], s30 offen nt lds
    s_add_u32 m0, s26, 36864
    s_add_u32 s30, s21, 67584
    s_waitcnt vmcnt(24)
    buffer_load_dwordx4 v4, s[4:7], s30 offen nt lds
    s_add_u32 m0, s26, 37888
    s_add_u32 s30, s21, 68096
    s_waitcnt vmcnt(24)
    buffer_load_dwordx4 v5, s[4:7], s30 offen nt lds
    s_add_u32 m0, s26, 38912
    s_add_u32 s30, s21, 68608
    s_waitcnt vmcnt(24)
    buffer_load_dwordx4 v6, s[4:7], s30 offen nt lds
    s_add_u32 m0, s26, 39936
    s_add_u32 s30, s21, 69120
    s_waitcnt vmcnt(24)
    buffer_load_dwordx4 v7, s[4:7], s30 offen nt lds
    s_add_u32 m0, s26, 65536
    s_add_u32 s30, s21, 32768
    s_waitcnt vmcnt(24)
    buffer_load_dwordx4 v4, s[4:7], s30 offen nt lds
    s_add_u32 m0, s26, 66560
    s_add_u32 s30, s21, 33280
    s_waitcnt vmcnt(24)
    buffer_load_dwordx4 v5, s[4:7], s30 offen nt lds
    s_add_u32 m0, s26, 67584
    s_add_u32 s30, s21, 33792
    s_waitcnt vmcnt(24)
    buffer_load_dwordx4 v6, s[4:7], s30 offen nt lds
    s_add_u32 m0, s26, 68608
    s_add_u32 s30, s21, 34304
    s_waitcnt vmcnt(24)
    buffer_load_dwordx4 v7, s[4:7], s30 offen nt lds
    s_add_u32 m0, s26, 69632
    s_add_u32 s30, s21, 98304
    s_waitcnt vmcnt(24)
    buffer_load_dwordx4 v4, s[4:7], s30 offen nt lds
    s_add_u32 m0, s26, 70656
    s_add_u32 s30, s21, 98816
    s_waitcnt vmcnt(24)
    buffer_load_dwordx4 v5, s[4:7], s30 offen nt lds
    s_add_u32 m0, s26, 71680
    s_add_u32 s30, s21, 99328
    s_waitcnt vmcnt(24)
    buffer_load_dwordx4 v6, s[4:7], s30 offen nt lds
    s_add_u32 m0, s26, 72704
    s_add_u32 s30, s21, 99840
    s_waitcnt vmcnt(24)
    buffer_load_dwordx4 v7, s[4:7], s30 offen nt lds
    s_add_u32 m0, s26, 98304
    s_add_u32 s30, s21, 34816
    s_waitcnt vmcnt(24)
    s_add_i32 s27, s24, 0
    s_max_i32 s22, s22, s27
    v_mov_b32 v13, s22
    ds_write_b32 v12, v13
    buffer_load_dwordx4 v4, s[4:7], s30 offen nt lds
    s_add_u32 m0, s26, 99328
    s_add_u32 s30, s21, 35328
    s_waitcnt vmcnt(24)
    buffer_load_dwordx4 v5, s[4:7], s30 offen nt lds
    s_add_u32 m0, s26, 100352
    s_add_u32 s30, s21, 35840
    s_waitcnt vmcnt(24)
    buffer_load_dwordx4 v6, s[4:7], s30 offen nt lds
    s_add_u32 m0, s26, 101376
    s_add_u32 s30, s21, 36352
    s_waitcnt vmcnt(24)
    buffer_load_dwordx4 v7, s[4:7], s30 offen nt lds
    s_add_u32 m0, s26, 102400
    s_add_u32 s30, s21, 100352
    s_waitcnt vmcnt(24)
    buffer_load_dwordx4 v4, s[4:7], s30 offen nt lds
    s_add_u32 m0, s26, 103424
    s_add_u32 s30, s21, 100864
    s_waitcnt vmcnt(24)
    buffer_load_dwordx4 v5, s[4:7], s30 offen nt lds
    s_add_u32 m0, s26, 104448
    s_add_u32 s30, s21, 101376
    s_waitcnt vmcnt(24)
    buffer_load_dwordx4 v6, s[4:7], s30 offen nt lds
    s_add_u32 m0, s26, 105472
    s_add_u32 s30, s21, 101888
    s_waitcnt vmcnt(24)
    buffer_load_dwordx4 v7, s[4:7], s30 offen nt lds
    s_add_u32 m0, s26, 8192
    s_add_u32 s30, s21, 0
    s_waitcnt vmcnt(24)
    buffer_load_dwordx4 v8, s[8:11], s30 offen nt lds
    s_add_u32 m0, s26, 9216
    s_add_u32 s30, s21, 512
    s_waitcnt vmcnt(24)
    buffer_load_dwordx4 v9, s[8:11], s30 offen nt lds
    s_add_u32 m0, s26, 10240
    s_add_u32 s30, s21, 1024
    s_waitcnt vmcnt(24)
    buffer_load_dwordx4 v8, s[8:11], s30 offen nt lds
    s_add_u32 m0, s26, 11264
    s_add_u32 s30, s21, 1536
    s_waitcnt vmcnt(24)
    buffer_load_dwordx4 v9, s[8:11], s30 offen nt lds
    s_add_u32 m0, s26, 12288
    s_add_u32 s30, s21, 65536
    s_waitcnt vmcnt(24)
    buffer_load_dwordx4 v8, s[8:11], s30 offen nt lds
    s_add_u32 m0, s26, 13312
    s_add_u32 s30, s21, 66048
    s_waitcnt vmcnt(24)
    buffer_load_dwordx4 v9, s[8:11], s30 offen nt lds
    s_add_u32 m0, s26, 14336
    s_add_u32 s30, s21, 66560
    s_waitcnt vmcnt(24)
    buffer_load_dwordx4 v8, s[8:11], s30 offen nt lds
    s_add_u32 m0, s26, 15360
    s_add_u32 s30, s21, 67072
    s_waitcnt vmcnt(24)
    buffer_load_dwordx4 v9, s[8:11], s30 offen nt lds
    s_add_u32 m0, s26, 40960
    s_add_u32 s30, s21, 2048
    s_waitcnt vmcnt(24)
    buffer_load_dwordx4 v8, s[8:11], s30 offen nt lds
    s_add_u32 m0, s26, 41984
    s_add_u32 s30, s21, 2560
    s_waitcnt vmcnt(24)
    buffer_load_dwordx4 v9, s[8:11], s30 offen nt lds
    s_add_u32 m0, s26, 43008
    s_add_u32 s30, s21, 3072
    s_waitcnt vmcnt(24)
    buffer_load_dwordx4 v8, s[8:11], s30 offen nt lds
    s_add_u32 m0, s26, 44032
    s_add_u32 s30, s21, 3584
    s_waitcnt vmcnt(24)
    buffer_load_dwordx4 v9, s[8:11], s30 offen nt lds
    s_add_u32 m0, s26, 45056
    s_add_u32 s30, s21, 67584
    s_waitcnt vmcnt(24)
    buffer_load_dwordx4 v8, s[8:11], s30 offen nt lds
    s_add_u32 m0, s26, 46080
    s_add_u32 s30, s21, 68096
    s_waitcnt vmcnt(24)
    buffer_load_dwordx4 v9, s[8:11], s30 offen nt lds
    s_add_u32 m0, s26, 47104
    s_add_u32 s30, s21, 68608
    s_waitcnt vmcnt(24)
    buffer_load_dwordx4 v8, s[8:11], s30 offen nt lds
    s_add_u32 m0, s26, 48128
    s_add_u32 s30, s21, 69120
    s_waitcnt vmcnt(24)
    buffer_load_dwordx4 v9, s[8:11], s30 offen nt lds
    s_add_u32 m0, s26, 73728
    s_add_u32 s30, s21, 32768
    s_waitcnt vmcnt(24)
    buffer_load_dwordx4 v8, s[8:11], s30 offen nt lds
    s_add_u32 m0, s26, 74752
    s_add_u32 s30, s21, 33280
    s_waitcnt vmcnt(24)
    buffer_load_dwordx4 v9, s[8:11], s30 offen nt lds
    s_add_u32 m0, s26, 75776
    s_add_u32 s30, s21, 33792
    s_waitcnt vmcnt(24)
    buffer_load_dwordx4 v8, s[8:11], s30 offen nt lds
    s_add_u32 m0, s26, 76800
    s_add_u32 s30, s21, 34304
    s_waitcnt vmcnt(24)
    buffer_load_dwordx4 v9, s[8:11], s30 offen nt lds
    s_add_u32 m0, s26, 77824
    s_add_u32 s30, s21, 98304
    s_waitcnt vmcnt(24)
    buffer_load_dwordx4 v8, s[8:11], s30 offen nt lds
    s_add_u32 m0, s26, 78848
    s_add_u32 s30, s21, 98816
    s_waitcnt vmcnt(24)
    buffer_load_dwordx4 v9, s[8:11], s30 offen nt lds
    s_add_u32 m0, s26, 79872
    s_add_u32 s30, s21, 99328
    s_waitcnt vmcnt(24)
    buffer_load_dwordx4 v8, s[8:11], s30 offen nt lds
    s_add_u32 m0, s26, 80896
    s_add_u32 s30, s21, 99840
    s_waitcnt vmcnt(24)
    buffer_load_dwordx4 v9, s[8:11], s30 offen nt lds
    s_add_u32 m0, s26, 106496
    s_add_u32 s30, s21, 34816
    s_waitcnt vmcnt(24)
    s_add_i32 s27, s24, 1
    s_max_i32 s22, s22, s27
    v_mov_b32 v13, s22
    ds_write_b32 v12, v13
    ds_read_b32 v16, v15
    buffer_load_dwordx4 v8, s[8:11], s30 offen nt lds
    s_add_u32 m0, s26, 107520
    s_add_u32 s30, s21, 35328
    s_waitcnt vmcnt(24)
    buffer_load_dwordx4 v9, s[8:11], s30 offen nt lds
    s_add_u32 m0, s26, 108544
    s_add_u32 s30, s21, 35840
    s_waitcnt vmcnt(24)
    buffer_load_dwordx4 v8, s[8:11], s30 offen nt lds
    s_add_u32 m0, s26, 109568
    s_add_u32 s30, s21, 36352
    s_waitcnt vmcnt(24)
    buffer_load_dwordx4 v9, s[8:11], s30 offen nt lds
    s_add_u32 m0, s26, 110592
    s_add_u32 s30, s21, 100352
    s_waitcnt vmcnt(24)
    buffer_load_dwordx4 v8, s[8:11], s30 offen nt lds
    s_add_u32 m0, s26, 111616
    s_add_u32 s30, s21, 100864
    s_waitcnt vmcnt(24)
    buffer_load_dwordx4 v9, s[8:11], s30 offen nt lds
    s_add_u32 m0, s26, 112640
    s_add_u32 s30, s21, 101376
    s_waitcnt vmcnt(24)
    buffer_load_dwordx4 v8, s[8:11], s30 offen nt lds
    s_add_u32 m0, s26, 113664
    s_add_u32 s30, s21, 101888
    s_waitcnt vmcnt(24)
    buffer_load_dwordx4 v9, s[8:11], s30 offen nt lds
    s_add_u32 s20, s20, 1
    s_add_u32 s21, s20, s19
    s_and_b32 s21, s21, 15
    s_and_b32 s27, s20, 16
    s_lshl_b32 s29, s27, 15
    s_bfe_u32 s27, s21, 65536
    s_lshl_b32 s27, s27, 18
    s_or_b32 s29, s29, s27
    s_bfe_u32 s27, s21, 65537
    s_lshl_b32 s27, s27, 17
    s_or_b32 s29, s29, s27
    s_bfe_u32 s27, s21, 65538
    s_lshl_b32 s27, s27, 12
    s_or_b32 s29, s29, s27
    s_bfe_u32 s27, s21, 65539
    s_lshl_b32 s27, s27, 14
    s_or_b32 s29, s29, s27
    s_mov_b32 s21, s29
    s_cmp_lt_u32 s20, 32
    s_cbranch_scc1 L_ld
    s_branch L_drain
L_var24:
    s_add_u32 m0, s26, 0
    s_add_u32 s30, s21, 0
    s_waitcnt vmcnt(23)
    buffer_load_dwordx4 v4, s[4:7], s30 offen nt lds
    s_add_u32 m0, s26, 1024
    s_add_u32 s30, s21, 512
    s_waitcnt vmcnt(23)
    buffer_load_dwordx4 v5, s[4:7], s30 offen nt lds
    s_add_u32 m0, s26, 2048
    s_add_u32 s30, s21, 1024
    s_waitcnt vmcnt(23)
    buffer_load_dwordx4 v6, s[4:7], s30 offen nt lds
    s_add_u32 m0, s26, 3072
    s_add_u32 s30, s21, 1536
    s_waitcnt vmcnt(23)
    buffer_load_dwordx4 v7, s[4:7], s30 offen nt lds
    s_add_u32 m0, s26, 4096
    s_add_u32 s30, s21, 65536
    s_waitcnt vmcnt(23)
    buffer_load_dwordx4 v4, s[4:7], s30 offen nt lds
    s_add_u32 m0, s26, 5120
    s_add_u32 s30, s21, 66048
    s_waitcnt vmcnt(23)
    buffer_load_dwordx4 v5, s[4:7], s30 offen nt lds
    s_add_u32 m0, s26, 6144
    s_add_u32 s30, s21, 66560
    s_waitcnt vmcnt(23)
    buffer_load_dwordx4 v6, s[4:7], s30 offen nt lds
    s_add_u32 m0, s26, 7168
    s_add_u32 s30, s21, 67072
    s_waitcnt vmcnt(23)
    buffer_load_dwordx4 v7, s[4:7], s30 offen nt lds
    s_add_u32 m0, s26, 32768
    s_add_u32 s30, s21, 2048
    s_waitcnt vmcnt(23)
    buffer_load_dwordx4 v4, s[4:7], s30 offen nt lds
    s_add_u32 m0, s26, 33792
    s_add_u32 s30, s21, 2560
    s_waitcnt vmcnt(23)
    buffer_load_dwordx4 v5, s[4:7], s30 offen nt lds
    s_add_u32 m0, s26, 34816
    s_add_u32 s30, s21, 3072
    s_waitcnt vmcnt(23)
    buffer_load_dwordx4 v6, s[4:7], s30 offen nt lds
    s_add_u32 m0, s26, 35840
    s_add_u32 s30, s21, 3584
    s_waitcnt vmcnt(23)
    buffer_load_dwordx4 v7, s[4:7], s30 offen nt lds
    s_add_u32 m0, s26, 36864
    s_add_u32 s30, s21, 67584
    s_waitcnt vmcnt(23)
    buffer_load_dwordx4 v4, s[4:7], s30 offen nt lds
    s_add_u32 m0, s26, 37888
    s_add_u32 s30, s21, 68096
    s_waitcnt vmcnt(23)
    buffer_load_dwordx4 v5, s[4:7], s30 offen nt lds
    s_add_u32 m0, s26, 38912
    s_add_u32 s30, s21, 68608
    s_waitcnt vmcnt(23)
    buffer_load_dwordx4 v6, s[4:7], s30 offen nt lds
    s_add_u32 m0, s26, 39936
    s_add_u32 s30, s21, 69120
    s_waitcnt vmcnt(23)
    buffer_load_dwordx4 v7, s[4:7], s30 offen nt lds
    s_add_u32 m0, s26, 65536
    s_add_u32 s30, s21, 32768
    s_waitcnt vmcnt(23)
    buffer_load_dwordx4 v4, s[4:7], s30 offen nt lds
    s_add_u32 m0, s26, 66560
    s_add_u32 s30, s21, 33280
    s_waitcnt vmcnt(23)
    buffer_load_dwordx4 v5, s[4:7], s30 offen nt lds
    s_add_u32 m0, s26, 67584
    s_add_u32 s30, s21, 33792
    s_waitcnt vmcnt(23)
    buffer_load_dwordx4 v6, s[4:7], s30 offen nt lds
    s_add_u32 m0, s26, 68608
    s_add_u32 s30, s21, 34304
    s_waitcnt vmcnt(23)
    buffer_load_dwordx4 v7, s[4:7], s30 offen nt lds
    s_add_u32 m0, s26, 69632
    s_add_u32 s30, s21, 98304
    s_waitcnt vmcnt(23)
    buffer_load_dwordx4 v4, s[4:7], s30 offen nt lds
    s_add_u32 m0, s26, 70656
    s_add_u32 s30, s21, 98816
    s_waitcnt vmcnt(23)
    buffer_load_dwordx4 v5, s[4:7], s30 offen nt lds
    s_add_u32 m0, s26, 71680
    s_add_u32 s30, s21, 99328
    s_waitcnt vmcnt(23)
    buffer_load_dwordx4 v6, s[4:7], s30 offen nt lds
    s_add_u32 m0, s26, 72704
    s_add_u32 s30, s21, 99840
    s_waitcnt vmcnt(23)
    s_add_i32 s27, s24, 0
    s_max_i32 s22, s22, s27
    v_mov_b32 v13, s22
    ds_write_b32 v12, v13
    buffer_load_dwordx4 v7, s[4:7], s30 offen nt lds
    s_add_u32 m0, s26, 98304
    s_add_u32 s30, s21, 34816
    s_waitcnt vmcnt(23)
    buffer_load_dwordx4 v4, s[4:7], s30 offen nt lds
    s_add_u32 m0, s26, 99328
    s_add_u32 s30, s21, 35328
    s_waitcnt vmcnt(23)
    buffer_load_dwordx4 v5, s[4:7], s30 offen nt lds
    s_add_u32 m0, s26, 100352
    s_add_u32 s30, s21, 35840
    s_waitcnt vmcnt(23)
    buffer_load_dwordx4 v6, s[4:7], s30 offen nt lds
    s_add_u32 m0, s26, 101376
    s_add_u32 s30, s21, 36352
    s_waitcnt vmcnt(23)
    buffer_load_dwordx4 v7, s[4:7], s30 offen nt lds
    s_add_u32 m0, s26, 102400
    s_add_u32 s30, s21, 100352
    s_waitcnt vmcnt(23)
    buffer_load_dwordx4 v4, s[4:7], s30 offen nt lds
    s_add_u32 m0, s26, 103424
    s_add_u32 s30, s21, 100864
    s_waitcnt vmcnt(23)
    buffer_load_dwordx4 v5, s[4:7], s30 offen nt lds
    s_add_u32 m0, s26, 104448
    s_add_u32 s30, s21, 101376
    s_waitcnt vmcnt(23)
    buffer_load_dwordx4 v6, s[4:7], s30 offen nt lds
    s_add_u32 m0, s26, 105472
    s_add_u32 s30, s21, 101888
    s_waitcnt vmcnt(23)
    buffer_load_dwordx4 v7, s[4:7], s30 offen nt lds
    s_add_u32 m0, s26, 8192
    s_add_u32 s30, s21, 0
    s_waitcnt vmcnt(23)
    buffer_load_dwordx4 v8, s[8:11], s30 offen nt lds
    s_add_u32 m0, s26, 9216
    s_add_u32 s30, s21, 512
    s_waitcnt vmcnt(23)
    buffer_load_dwordx4 v9, s[8:11], s30 offen nt lds
    s_add_u32 m0, s26, 10240
    s_add_u32 s30, s21, 1024
    s_waitcnt vmcnt(23)
    buffer_load_dwordx4 v8, s[8:11], s30 offen nt lds
    s_add_u32 m0, s26, 11264
    s_add_u32 s30, s21, 1536
    s_waitcnt vmcnt(23)
    buffer_load_dwordx4 v9, s[8:11], s30 offen nt lds
    s_add_u32 m0, s26, 12288
    s_add_u32 s30, s21, 65536
    s_waitcnt vmcnt(23)
    buffer_load_dwordx4 v8, s[8:11], s30 offen nt lds
    s_add_u32 m0, s26, 13312
    s_add_u32 s30, s21, 66048
    s_waitcnt vmcnt(23)
    buffer_load_dwordx4 v9, s[8:11], s30 offen nt lds
    s_add_u32 m0, s26, 14336
    s_add_u32 s30, s21, 66560
    s_waitcnt vmcnt(23)
    buffer_load_dwordx4 v8, s[8:11], s30 offen nt lds
    s_add_u32 m0, s26, 15360
    s_add_u32 s30, s21, 67072
    s_waitcnt vmcnt(23)
    buffer_load_dwordx4 v9, s[8:11], s30 offen nt lds
    s_add_u32 m0, s26, 40960
    s_add_u32 s30, s21, 2048
    s_waitcnt vmcnt(23)
    buffer_load_dwordx4 v8, s[8:11], s30 offen nt lds
    s_add_u32 m0, s26, 41984
    s_add_u32 s30, s21, 2560
    s_waitcnt vmcnt(23)
    buffer_load_dwordx4 v9, s[8:11], s30 offen nt lds
    s_add_u32 m0, s26, 43008
    s_add_u32 s30, s21, 3072
    s_waitcnt vmcnt(23)
    buffer_load_dwordx4 v8, s[8:11], s30 offen nt lds
    s_add_u32 m0, s26, 44032
    s_add_u32 s30, s21, 3584
    s_waitcnt vmcnt(23)
    buffer_load_dwordx4 v9, s[8:11], s30 offen nt lds
    s_add_u32 m0, s26, 45056
    s_add_u32 s30, s21, 67584
    s_waitcnt vmcnt(23)
    buffer_load_dwordx4 v8, s[8:11], s30 offen nt lds
    s_add_u32 m0, s26, 46080
    s_add_u32 s30, s21, 68096
    s_waitcnt vmcnt(23)
    buffer_load_dwordx4 v9, s[8:11], s30 offen nt lds
    s_add_u32 m0, s26, 47104
    s_add_u32 s30, s21, 68608
    s_waitcnt vmcnt(23)
    buffer_load_dwordx4 v8, s[8:11], s30 offen nt lds
    s_add_u32 m0, s26, 48128
    s_add_u32 s30, s21, 69120
    s_waitcnt vmcnt(23)
    buffer_load_dwordx4 v9, s[8:11], s30 offen nt lds
    s_add_u32 m0, s26, 73728
    s_add_u32 s30, s21, 32768
    s_waitcnt vmcnt(23)
    buffer_load_dwordx4 v8, s[8:11], s30 offen nt lds
    s_add_u32 m0, s26, 74752
    s_add_u32 s30, s21, 33280
    s_waitcnt vmcnt(23)
    buffer_load_dwordx4 v9, s[8:11], s30 offen nt lds
    s_add_u32 m0, s26, 75776
    s_add_u32 s30, s21, 33792
    s_waitcnt vmcnt(23)
    buffer_load_dwordx4 v8, s[8:11], s30 offen nt lds
    s_add_u32 m0, s26, 76800
    s_add_u32 s30, s21, 34304
    s_waitcnt vmcnt(23)
    buffer_load_dwordx4 v9, s[8:11], s30 offen nt lds
    s_add_u32 m0, s26, 77824
    s_add_u32 s30, s21, 98304
    s_waitcnt vmcnt(23)
    buffer_load_dwordx4 v8, s[8:11], s30 offen nt lds
    s_add_u32 m0, s26, 78848
    s_add_u32 s30, s21, 98816
    s_waitcnt vmcnt(23)
    buffer_load_dwordx4 v9, s[8:11], s30 offen nt lds
    s_add_u32 m0, s26, 79872
    s_add_u32 s30, s21, 99328
    s_waitcnt vmcnt(23)
    buffer_load_dwordx4 v8, s[8:11], s30 offen nt lds
    s_add_u32 m0, s26, 80896
    s_add_u32 s30, s21, 99840
    s_waitcnt vmcnt(23)
    s_add_i32 s27, s24, 1
    s_max_i32 s22, s22, s27
    v_mov_b32 v13, s22
    ds_write_b32 v12, v13
    buffer_load_dwordx4 v9, s[8:11], s30 offen nt lds
    s_add_u32 m0, s26, 106496
    s_add_u32 s30, s21, 34816
    s_waitcnt vmcnt(23)
    ds_read_b32 v16, v15
    buffer_load_dwordx4 v8, s[8:11], s30 offen nt lds
    s_add_u32 m0, s26, 107520
    s_add_u32 s30, s21, 35328
    s_waitcnt vmcnt(23)
    buffer_load_dwordx4 v9, s[8:11], s30 offen nt lds
    s_add_u32 m0, s26, 108544
    s_add_u32 s30, s21, 35840
    s_waitcnt vmcnt(23)
    buffer_load_dwordx4 v8, s[8:11], s30 offen nt lds
    s_add_u32 m0, s26, 109568
    s_add_u32 s30, s21, 36352
    s_waitcnt vmcnt(23)
    buffer_load_dwordx4 v9, s[8:11], s30 offen nt lds
    s_add_u32 m0, s26, 110592
    s_add_u32 s30, s21, 100352
    s_waitcnt vmcnt(23)
    buffer_load_dwordx4 v8, s[8:11], s30 offen nt lds
    s_add_u32 m0, s26, 111616
    s_add_u32 s30, s21, 100864
    s_waitcnt vmcnt(23)
    buffer_load_dwordx4 v9, s[8:11], s30 offen nt lds
    s_add_u32 m0, s26, 112640
    s_add_u32 s30, s21, 101376
    s_waitcnt vmcnt(23)
    buffer_load_dwordx4 v8, s[8:11], s30 offen nt lds
    s_add_u32 m0, s26, 113664
    s_add_u32 s30, s21, 101888
    s_waitcnt vmcnt(23)
    buffer_load_dwordx4 v9, s[8:11], s30 offen nt lds
    s_add_u32 s20, s20, 1
    s_add_u32 s21, s20, s19
    s_and_b32 s21, s21, 15
    s_and_b32 s27, s20, 16
    s_lshl_b32 s29, s27, 15
    s_bfe_u32 s27, s21, 65536
    s_lshl_b32 s27, s27, 18
    s_or_b32 s29, s29, s27
    s_bfe_u32 s27, s21, 65537
    s_lshl_b32 s27, s27, 17
    s_or_b32 s29, s29, s27
    s_bfe_u32 s27, s21, 65538
    s_lshl_b32 s27, s27, 12
    s_or_b32 s29, s29, s27
    s_bfe_u32 s27, s21, 65539
    s_lshl_b32 s27, s27, 14
    s_or_b32 s29, s29, s27
    s_mov_b32 s21, s29
    s_cmp_lt_u32 s20, 32
    s_cbranch_scc1 L_ld
    s_branch L_drain
L_var23:
    s_add_u32 m0, s26, 0
    s_add_u32 s30, s21, 0
    s_waitcnt vmcnt(22)
    buffer_load_dwordx4 v4, s[4:7], s30 offen nt lds
    s_add_u32 m0, s26, 1024
    s_add_u32 s30, s21, 512
    s_waitcnt vmcnt(22)
    buffer_load_dwordx4 v5, s[4:7], s30 offen nt lds
    s_add_u32 m0, s26, 2048
    s_add_u32 s30, s21, 1024
    s_waitcnt vmcnt(22)
    buffer_load_dwordx4 v6, s[4:7], s30 offen nt lds
    s_add_u32 m0, s26, 3072
    s_add_u32 s30, s21, 1536
    s_waitcnt vmcnt(22)
    buffer_load_dwordx4 v7, s[4:7], s30 offen nt lds
    s_add_u32 m0, s26, 4096
    s_add_u32 s30, s21, 65536
    s_waitcnt vmcnt(22)
    buffer_load_dwordx4 v4, s[4:7], s30 offen nt lds
    s_add_u32 m0, s26, 5120
    s_add_u32 s30, s21, 66048
    s_waitcnt vmcnt(22)
    buffer_load_dwordx4 v5, s[4:7], s30 offen nt lds
    s_add_u32 m0, s26, 6144
    s_add_u32 s30, s21, 66560
    s_waitcnt vmcnt(22)
    buffer_load_dwordx4 v6, s[4:7], s30 offen nt lds
    s_add_u32 m0, s26, 7168
    s_add_u32 s30, s21, 67072
    s_waitcnt vmcnt(22)
    buffer_load_dwordx4 v7, s[4:7], s30 offen nt lds
    s_add_u32 m0, s26, 32768
    s_add_u32 s30, s21, 2048
    s_waitcnt vmcnt(22)
    buffer_load_dwordx4 v4, s[4:7], s30 offen nt lds
    s_add_u32 m0, s26, 33792
    s_add_u32 s30, s21, 2560
    s_waitcnt vmcnt(22)
    buffer_load_dwordx4 v5, s[4:7], s30 offen nt lds
    s_add_u32 m0, s26, 34816
    s_add_u32 s30, s21, 3072
    s_waitcnt vmcnt(22)
    buffer_load_dwordx4 v6, s[4:7], s30 offen nt lds
    s_add_u32 m0, s26, 35840
    s_add_u32 s30, s21, 3584
    s_waitcnt vmcnt(22)
    buffer_load_dwordx4 v7, s[4:7], s30 offen nt lds
    s_add_u32 m0, s26, 36864
    s_add_u32 s30, s21, 67584
    s_waitcnt vmcnt(22)
    buffer_load_dwordx4 v4, s[4:7], s30 offen nt lds
    s_add_u32 m0, s26, 37888
    s_add_u32 s30, s21, 68096
    s_waitcnt vmcnt(22)
    buffer_load_dwordx4 v5, s[4:7], s30 offen nt lds
    s_add_u32 m0, s26, 38912
    s_add_u32 s30, s21, 68608
    s_waitcnt vmcnt(22)
    buffer_load_dwordx4 v6, s[4:7], s30 offen nt lds
    s_add_u32 m0, s26, 39936
    s_add_u32 s30, s21, 69120
    s_waitcnt vmcnt(22)
    buffer_load_dwordx4 v7, s[4:7], s30 offen nt lds
    s_add_u32 m0, s26, 65536
    s_add_u32 s30, s21, 32768
    s_waitcnt vmcnt(22)
    buffer_load_dwordx4 v4, s[4:7], s30 offen nt lds
    s_add_u32 m0, s26, 66560
    s_add_u32 s30, s21, 33280
    s_waitcnt vmcnt(22)
    buffer_load_dwordx4 v5, s[4:7], s30 offen nt lds
    s_add_u32 m0, s26, 67584
    s_add_u32 s30, s21, 33792
    s_waitcnt vmcnt(22)
    buffer_load_dwordx4 v6, s[4:7], s30 offen nt lds
    s_add_u32 m0, s26, 68608
    s_add_u32 s30, s21, 34304
    s_waitcnt vmcnt(22)
    buffer_load_dwordx4 v7, s[4:7], s30 offen nt lds
    s_add_u32 m0, s26, 69632
    s_add_u32 s30, s21, 98304
    s_waitcnt vmcnt(22)
    buffer_load_dwordx4 v4, s[4:7], s30 offen nt lds
    s_add_u32 m0, s26, 70656
    s_add_u32 s30, s21, 98816
    s_waitcnt vmcnt(22)
    buffer_load_dwordx4 v5, s[4:7], s30 offen nt lds
    s_add_u32 m0, s26, 71680
    s_add_u32 s30, s21, 99328
    s_waitcnt vmcnt(22)
    s_add_i32 s27, s24, 0
    s_max_i32 s22, s22, s27
    v_mov_b32 v13, s22
    ds_write_b32 v12, v13
    buffer_load_dwordx4 v6, s[4:7], s30 offen nt lds
    s_add_u32 m0, s26, 72704
    s_add_u32 s30, s21, 99840
    s_waitcnt vmcnt(22)
    buffer_load_dwordx4 v7, s[4:7], s30 offen nt lds
    s_add_u32 m0, s26, 98304
    s_add_u32 s30, s21, 34816
    s_waitcnt vmcnt(22)
    buffer_load_dwordx4 v4, s[4:7], s30 offen nt lds
    s_add_u32 m0, s26, 99328
    s_add_u32 s30, s21, 35328
    s_waitcnt vmcnt(22)
    buffer_load_dwordx4 v5, s[4:7], s30 offen nt lds
    s_add_u32 m0, s26, 100352
    s_add_u32 s30, s21, 35840
    s_waitcnt vmcnt(22)
    buffer_load_dwordx4 v6, s[4:7], s30 offen nt lds
    s_add_u32 m0, s26, 101376
    s_add_u32 s30, s21, 36352
    s_waitcnt vmcnt(22)
    buffer_load_dwordx4 v7, s[4:7], s30 offen nt lds
    s_add_u32 m0, s26, 102400
    s_add_u32 s30, s21, 100352
    s_waitcnt vmcnt(22)
    buffer_load_dwordx4 v4, s[4:7], s30 offen nt lds
    s_add_u32 m0, s26, 103424
    s_add_u32 s30, s21, 100864
    s_waitcnt vmcnt(22)
    buffer_load_dwordx4 v5, s[4:7], s30 offen nt lds
    s_add_u32 m0, s26, 104448
    s_add_u32 s30, s21, 101376
    s_waitcnt vmcnt(22)
    buffer_load_dwordx4 v6, s[4:7], s30 offen nt lds
    s_add_u32 m0, s26, 105472
    s_add_u32 s30, s21, 101888
    s_waitcnt vmcnt(22)
    buffer_load_dwordx4 v7, s[4:7], s30 offen nt lds
    s_add_u32 m0, s26, 8192
    s_add_u32 s30, s21, 0
    s_waitcnt vmcnt(22)
    buffer_load_dwordx4 v8, s[8:11], s30 offen nt lds
    s_add_u32 m0, s26, 9216
    s_add_u32 s30, s21, 512
    s_waitcnt vmcnt(22)
    buffer_load_dwordx4 v9, s[8:11], s30 offen nt lds
    s_add_u32 m0, s26, 10240
    s_add_u32 s30, s21, 1024
    s_waitcnt vmcnt(22)
    buffer_load_dwordx4 v8, s[8:11], s30 offen nt lds
    s_add_u32 m0, s26, 11264
    s_add_u32 s30, s21, 1536
    s_waitcnt vmcnt(22)
    buffer_load_dwordx4 v9, s[8:11], s30 offen nt lds
    s_add_u32 m0, s26, 12288
    s_add_u32 s30, s21, 65536
    s_waitcnt vmcnt(22)
    buffer_load_dwordx4 v8, s[8:11], s30 offen nt lds
    s_add_u32 m0, s26, 13312
    s_add_u32 s30, s21, 66048
    s_waitcnt vmcnt(22)
    buffer_load_dwordx4 v9, s[8:11], s30 offen nt lds
    s_add_u32 m0, s26, 14336
    s_add_u32 s30, s21, 66560
    s_waitcnt vmcnt(22)
    buffer_load_dwordx4 v8, s[8:11], s30 offen nt lds
    s_add_u32 m0, s26, 15360
    s_add_u32 s30, s21, 67072
    s_waitcnt vmcnt(22)
    buffer_load_dwordx4 v9, s[8:11], s30 offen nt lds
    s_add_u32 m0, s26, 40960
    s_add_u32 s30, s21, 2048
    s_waitcnt vmcnt(22)
    buffer_load_dwordx4 v8, s[8:11], s30 offen nt lds
    s_add_u32 m0, s26, 41984
    s_add_u32 s30, s21, 2560
    s_waitcnt vmcnt(22)
    buffer_load_dwordx4 v9, s[8:11], s30 offen nt lds
    s_add_u32 m0, s26, 43008
    s_add_u32 s30, s21, 3072
    s_waitcnt vmcnt(22)
    buffer_load_dwordx4 v8, s[8:11], s30 offen nt lds
    s_add_u32 m0, s26, 44032
    s_add_u32 s30, s21, 3584
    s_waitcnt vmcnt(22)
    buffer_load_dwordx4 v9, s[8:11], s30 offen nt lds
    s_add_u32 m0, s26, 45056
    s_add_u32 s30, s21, 67584
    s_waitcnt vmcnt(22)
    buffer_load_dwordx4 v8, s[8:11], s30 offen nt lds
    s_add_u32 m0, s26, 46080
    s_add_u32 s30, s21, 68096
    s_waitcnt vmcnt(22)
    buffer_load_dwordx4 v9, s[8:11], s30 offen nt lds
    s_add_u32 m0, s26, 47104
    s_add_u32 s30, s21, 68608
    s_waitcnt vmcnt(22)
    buffer_load_dwordx4 v8, s[8:11], s30 offen nt lds
    s_add_u32 m0, s26, 48128
    s_add_u32 s30, s21, 69120
    s_waitcnt vmcnt(22)
    buffer_load_dwordx4 v9, s[8:11], s30 offen nt lds
    s_add_u32 m0, s26, 73728
    s_add_u32 s30, s21, 32768
    s_waitcnt vmcnt(22)
    buffer_load_dwordx4 v8, s[8:11], s30 offen nt lds
    s_add_u32 m0, s26, 74752
    s_add_u32 s30, s21, 33280
    s_waitcnt vmcnt(22)
    buffer_load_dwordx4 v9, s[8:11], s30 offen nt lds
    s_add_u32 m0, s26, 75776
    s_add_u32 s30, s21, 33792
    s_waitcnt vmcnt(22)
    buffer_load_dwordx4 v8, s[8:11], s30 offen nt lds
    s_add_u32 m0, s26, 76800
    s_add_u32 s30, s21, 34304
    s_waitcnt vmcnt(22)
    buffer_load_dwordx4 v9, s[8:11], s30 offen nt lds
    s_add_u32 m0, s26, 77824
    s_add_u32 s30, s21, 98304
    s_waitcnt vmcnt(22)
    buffer_load_dwordx4 v8, s[8:11], s30 offen nt lds
    s_add_u32 m0, s26, 78848
    s_add_u32 s30, s21, 98816
    s_waitcnt vmcnt(22)
    buffer_load_dwordx4 v9, s[8:11], s30 offen nt lds
    s_add_u32 m0, s26, 79872
    s_add_u32 s30, s21, 99328
    s_waitcnt vmcnt(22)
    s_add_i32 s27, s24, 1
    s_max_i32 s22, s22, s27
    v_mov_b32 v13, s22
    ds_write_b32 v12, v13
    buffer_load_dwordx4 v8, s[8:11], s30 offen nt lds
    s_add_u32 m0, s26, 80896
    s_add_u32 s30, s21, 99840
    s_waitcnt vmcnt(22)
    buffer_load_dwordx4 v9, s[8:11], s30 offen nt lds
    s_add_u32 m0, s26, 106496
    s_add_u32 s30, s21, 34816
    s_waitcnt vmcnt(22)
    ds_read_b32 v16, v15
    buffer_load_dwordx4 v8, s[8:11], s30 offen nt lds
    s_add_u32 m0, s26, 107520
    s_add_u32 s30, s21, 35328
    s_waitcnt vmcnt(22)
    buffer_load_dwordx4 v9, s[8:11], s30 offen nt lds
    s_add_u32 m0, s26, 108544
    s_add_u32 s30, s21, 35840
    s_waitcnt vmcnt(22)
    buffer_load_dwordx4 v8, s[8:11], s30 offen nt lds
    s_add_u32 m0, s26, 109568
    s_add_u32 s30, s21, 36352
    s_waitcnt vmcnt(22)
    buffer_load_dwordx4 v9, s[8:11], s30 offen nt lds
    s_add_u32 m0, s26, 110592
    s_add_u32 s30, s21, 100352
    s_waitcnt vmcnt(22)
    buffer_load_dwordx4 v8, s[8:11], s30 offen nt lds
    s_add_u32 m0, s26, 111616
    s_add_u32 s30, s21, 100864
    s_waitcnt vmcnt(22)
    buffer_load_dwordx4 v9, s[8:11], s30 offen nt lds
    s_add_u32 m0, s26, 112640
    s_add_u32 s30, s21, 101376
    s_waitcnt vmcnt(22)
    buffer_load_dwordx4 v8, s[8:11], s30 offen nt lds
    s_add_u32 m0, s26, 113664
    s_add_u32 s30, s21, 101888
    s_waitcnt vmcnt(22)
    buffer_load_dwordx4 v9, s[8:11], s30 offen nt lds
    s_add_u32 s20, s20, 1
    s_add_u32 s21, s20, s19
    s_and_b32 s21, s21, 15
    s_and_b32 s27, s20, 16
    s_lshl_b32 s29, s27, 15
    s_bfe_u32 s27, s21, 65536
    s_lshl_b32 s27, s27, 18
    s_or_b32 s29, s29, s27
    s_bfe_u32 s27, s21, 65537
    s_lshl_b32 s27, s27, 17
    s_or_b32 s29, s29, s27
    s_bfe_u32 s27, s21, 65538
    s_lshl_b32 s27, s27, 12
    s_or_b32 s29, s29, s27
    s_bfe_u32 s27, s21, 65539
    s_lshl_b32 s27, s27, 14
    s_or_b32 s29, s29, s27
    s_mov_b32 s21, s29
    s_cmp_lt_u32 s20, 32
    s_cbranch_scc1 L_ld
    s_branch L_drain
L_var22:
    s_add_u32 m0, s26, 0
    s_add_u32 s30, s21, 0
    s_waitcnt vmcnt(21)
    buffer_load_dwordx4 v4, s[4:7], s30 offen nt lds
    s_add_u32 m0, s26, 1024
    s_add_u32 s30, s21, 512
    s_waitcnt vmcnt(21)
    buffer_load_dwordx4 v5, s[4:7], s30 offen nt lds
    s_add_u32 m0, s26, 2048
    s_add_u32 s30, s21, 1024
    s_waitcnt vmcnt(21)
    buffer_load_dwordx4 v6, s[4:7], s30 offen nt lds
    s_add_u32 m0, s26, 3072
    s_add_u32 s30, s21, 1536
    s_waitcnt vmcnt(21)
    buffer_load_dwordx4 v7, s[4:7], s30 offen nt lds
    s_add_u32 m0, s26, 4096
    s_add_u32 s30, s21, 65536
    s_waitcnt vmcnt(21)
    buffer_load_dwordx4 v4, s[4:7], s30 offen nt lds
    s_add_u32 m0, s26, 5120
    s_add_u32 s30, s21, 66048
    s_waitcnt vmcnt(21)
    buffer_load_dwordx4 v5, s[4:7], s30 offen nt lds
    s_add_u32 m0, s26, 6144
    s_add_u32 s30, s21, 66560
    s_waitcnt vmcnt(21)
    buffer_load_dwordx4 v6, s[4:7], s30 offen nt lds
    s_add_u32 m0, s26, 7168
    s_add_u32 s30, s21, 67072
    s_waitcnt vmcnt(21)
    buffer_load_dwordx4 v7, s[4:7], s30 offen nt lds
    s_add_u32 m0, s26, 32768
    s_add_u32 s30, s21, 2048
    s_waitcnt vmcnt(21)
    buffer_load_dwordx4 v4, s[4:7], s30 offen nt lds
    s_add_u32 m0, s26, 33792
    s_add_u32 s30, s21, 2560
    s_waitcnt vmcnt(21)
    buffer_load_dwordx4 v5, s[4:7], s30 offen nt lds
    s_add_u32 m0, s26, 34816
    s_add_u32 s30, s21, 3072
    s_waitcnt vmcnt(21)
    buffer_load_dwordx4 v6, s[4:7], s30 offen nt lds
    s_add_u32 m0, s26, 35840
    s_add_u32 s30, s21, 3584
    s_waitcnt vmcnt(21)
    buffer_load_dwordx4 v7, s[4:7], s30 offen nt lds
    s_add_u32 m0, s26, 36864
    s_add_u32 s30, s21, 67584
    s_waitcnt vmcnt(21)
    buffer_load_dwordx4 v4, s[4:7], s30 offen nt lds
    s_add_u32 m0, s26, 37888
    s_add_u32 s30, s21, 68096
    s_waitcnt vmcnt(21)
    buffer_load_dwordx4 v5, s[4:7], s30 offen nt lds
    s_add_u32 m0, s26, 38912
    s_add_u32 s30, s21, 68608
    s_waitcnt vmcnt(21)
    buffer_load_dwordx4 v6, s[4:7], s30 offen nt lds
    s_add_u32 m0, s26, 39936
    s_add_u32 s30, s21, 69120
    s_waitcnt vmcnt(21)
    buffer_load_dwordx4 v7, s[4:7], s30 offen nt lds
    s_add_u32 m0, s26, 65536
    s_add_u32 s30, s21, 32768
    s_waitcnt vmcnt(21)
    buffer_load_dwordx4 v4, s[4:7], s30 offen nt lds
    s_add_u32 m0, s26, 66560
    s_add_u32 s30, s21, 33280
    s_waitcnt vmcnt(21)
    buffer_load_dwordx4 v5, s[4:7], s30 offen nt lds
    s_add_u32 m0, s26, 67584
    s_add_u32 s30, s21, 33792
    s_waitcnt vmcnt(21)
    buffer_load_dwordx4 v6, s[4:7], s30 offen nt lds
    s_add_u32 m0, s26, 68608
    s_add_u32 s30, s21, 34304
    s_waitcnt vmcnt(21)
    buffer_load_dwordx4 v7, s[4:7], s30 offen nt lds
    s_add_u32 m0, s26, 69632
    s_add_u32 s30, s21, 98304
    s_waitcnt vmcnt(21)
    buffer_load_dwordx4 v4, s[4:7], s30 offen nt lds
    s_add_u32 m0, s26, 70656
    s_add_u32 s30, s21, 98816
    s_waitcnt vmcnt(21)
    s_add_i32 s27, s24, 0
    s_max_i32 s22, s22, s27
    v_mov_b32 v13, s22
    ds_write_b32 v12, v13
    buffer_load_dwordx4 v5, s[4:7], s30 offen nt lds
    s_add_u32 m0, s26, 71680
    s_add_u32 s30, s21, 99328
    s_waitcnt vmcnt(21)
    buffer_load_dwordx4 v6, s[4:7], s30 offen nt lds
    s_add_u32 m0, s26, 72704
    s_add_u32 s30, s21, 99840
    s_waitcnt vmcnt(21)
    buffer_load_dwordx4 v7, s[4:7], s30 offen nt lds
    s_add_u32 m0, s26, 98304
    s_add_u32 s30, s21, 34816
    s_waitcnt vmcnt(21)
    buffer_load_dwordx4 v4, s[4:7], s30 offen nt lds
    s_add_u32 m0, s26, 99328
    s_add_u32 s30, s21, 35328
    s_waitcnt vmcnt(21)
    buffer_load_dwordx4 v5, s[4:7], s30 offen nt lds
    s_add_u32 m0, s26, 100352
    s_add_u32 s30, s21, 35840
    s_waitcnt vmcnt(21)
    buffer_load_dwordx4 v6, s[4:7], s30 offen nt lds
    s_add_u32 m0, s26, 101376
    s_add_u32 s30, s21, 36352
    s_waitcnt vmcnt(21)
    buffer_load_dwordx4 v7, s[4:7], s30 offen nt lds
    s_add_u32 m0, s26, 102400
    s_add_u32 s30, s21, 100352
    s_waitcnt vmcnt(21)
    buffer_load_dwordx4 v4, s[4:7], s30 offen nt lds
    s_add_u32 m0, s26, 103424
    s_add_u32 s30, s21, 100864
    s_waitcnt vmcnt(21)
    buffer_load_dwordx4 v5, s[4:7], s30 offen nt lds
    s_add_u32 m0, s26, 104448
    s_add_u32 s30, s21, 101376
    s_waitcnt vmcnt(21)
    buffer_load_dwordx4 v6, s[4:7], s30 offen nt lds
    s_add_u32 m0, s26, 105472
    s_add_u32 s30, s21, 101888
    s_waitcnt vmcnt(21)
    buffer_load_dwordx4 v7, s[4:7], s30 offen nt lds
    s_add_u32 m0, s26, 8192
    s_add_u32 s30, s21, 0
    s_waitcnt vmcnt(21)
    buffer_load_dwordx4 v8, s[8:11], s30 offen nt lds
    s_add_u32 m0, s26, 9216
    s_add_u32 s30, s21, 512
    s_waitcnt vmcnt(21)
    buffer_load_dwordx4 v9, s[8:11], s30 offen nt lds
    s_add_u32 m0, s26, 10240
    s_add_u32 s30, s21, 1024
    s_waitcnt vmcnt(21)
    buffer_load_dwordx4 v8, s[8:11], s30 offen nt lds
    s_add_u32 m0, s26, 11264
    s_add_u32 s30, s21, 1536
    s_waitcnt vmcnt(21)
    buffer_load_dwordx4 v9, s[8:11], s30 offen nt lds
    s_add_u32 m0, s26, 12288
    s_add_u32 s30, s21, 65536
    s_waitcnt vmcnt(21)
    buffer_load_dwordx4 v8, s[8:11], s30 offen nt lds
    s_add_u32 m0, s26, 13312
    s_add_u32 s30, s21, 66048
    s_waitcnt vmcnt(21)
    buffer_load_dwordx4 v9, s[8:11], s30 offen nt lds
    s_add_u32 m0, s26, 14336
    s_add_u32 s30, s21, 66560
    s_waitcnt vmcnt(21)
    buffer_load_dwordx4 v8, s[8:11], s30 offen nt lds
    s_add_u32 m0, s26, 15360
    s_add_u32 s30, s21, 67072
    s_waitcnt vmcnt(21)
    buffer_load_dwordx4 v9, s[8:11], s30 offen nt lds
    s_add_u32 m0, s26, 40960
    s_add_u32 s30, s21, 2048
    s_waitcnt vmcnt(21)
    buffer_load_dwordx4 v8, s[8:11], s30 offen nt lds
    s_add_u32 m0, s26, 41984
    s_add_u32 s30, s21, 2560
    s_waitcnt vmcnt(21)
    buffer_load_dwordx4 v9, s[8:11], s30 offen nt lds
    s_add_u32 m0, s26, 43008
    s_add_u32 s30, s21, 3072
    s_waitcnt vmcnt(21)
    buffer_load_dwordx4 v8, s[8:11], s30 offen nt lds
    s_add_u32 m0, s26, 44032
    s_add_u32 s30, s21, 3584
    s_waitcnt vmcnt(21)
    buffer_load_dwordx4 v9, s[8:11], s30 offen nt lds
    s_add_u32 m0, s26, 45056
    s_add_u32 s30, s21, 67584
    s_waitcnt vmcnt(21)
    buffer_load_dwordx4 v8, s[8:11], s30 offen nt lds
    s_add_u32 m0, s26, 46080
    s_add_u32 s30, s21, 68096
    s_waitcnt vmcnt(21)
    buffer_load_dwordx4 v9, s[8:11], s30 offen nt lds
    s_add_u32 m0, s26, 47104
    s_add_u32 s30, s21, 68608
    s_waitcnt vmcnt(21)
    buffer_load_dwordx4 v8, s[8:11], s30 offen nt lds
    s_add_u32 m0, s26, 48128
    s_add_u32 s30, s21, 69120
    s_waitcnt vmcnt(21)
    buffer_load_dwordx4 v9, s[8:11], s30 offen nt lds
    s_add_u32 m0, s26, 73728
    s_add_u32 s30, s21, 32768
    s_waitcnt vmcnt(21)
    buffer_load_dwordx4 v8, s[8:11], s30 offen nt lds
    s_add_u32 m0, s26, 74752
    s_add_u32 s30, s21, 33280
    s_waitcnt vmcnt(21)
    buffer_load_dwordx4 v9, s[8:11], s30 offen nt lds
    s_add_u32 m0, s26, 75776
    s_add_u32 s30, s21, 33792
    s_waitcnt vmcnt(21)
    buffer_load_dwordx4 v8, s[8:11], s30 offen nt lds
    s_add_u32 m0, s26, 76800
    s_add_u32 s30, s21, 34304
    s_waitcnt vmcnt(21)
    buffer_load_dwordx4 v9, s[8:11], s30 offen nt lds
    s_add_u32 m0, s26, 77824
    s_add_u32 s30, s21, 98304
    s_waitcnt vmcnt(21)
    buffer_load_dwordx4 v8, s[8:11], s30 offen nt lds
    s_add_u32 m0, s26, 78848
    s_add_u32 s30, s21, 98816
    s_waitcnt vmcnt(21)
    s_add_i32 s27, s24, 1
    s_max_i32 s22, s22, s27
    v_mov_b32 v13, s22
    ds_write_b32 v12, v13
    buffer_load_dwordx4 v9, s[8:11], s30 offen nt lds
    s_add_u32 m0, s26, 79872
    s_add_u32 s30, s21, 99328
    s_waitcnt vmcnt(21)
    buffer_load_dwordx4 v8, s[8:11], s30 offen nt lds
    s_add_u32 m0, s26, 80896
    s_add_u32 s30, s21, 99840
    s_waitcnt vmcnt(21)
    buffer_load_dwordx4 v9, s[8:11], s30 offen nt lds
    s_add_u32 m0, s26, 106496
    s_add_u32 s30, s21, 34816
    s_waitcnt vmcnt(21)
    ds_read_b32 v16, v15
    buffer_load_dwordx4 v8, s[8:11], s30 offen nt lds
    s_add_u32 m0, s26, 107520
    s_add_u32 s30, s21, 35328
    s_waitcnt vmcnt(21)
    buffer_load_dwordx4 v9, s[8:11], s30 offen nt lds
    s_add_u32 m0, s26, 108544
    s_add_u32 s30, s21, 35840
    s_waitcnt vmcnt(21)
    buffer_load_dwordx4 v8, s[8:11], s30 offen nt lds
    s_add_u32 m0, s26, 109568
    s_add_u32 s30, s21, 36352
    s_waitcnt vmcnt(21)
    buffer_load_dwordx4 v9, s[8:11], s30 offen nt lds
    s_add_u32 m0, s26, 110592
    s_add_u32 s30, s21, 100352
    s_waitcnt vmcnt(21)
    buffer_load_dwordx4 v8, s[8:11], s30 offen nt lds
    s_add_u32 m0, s26, 111616
    s_add_u32 s30, s21, 100864
    s_waitcnt vmcnt(21)
    buffer_load_dwordx4 v9, s[8:11], s30 offen nt lds
    s_add_u32 m0, s26, 112640
    s_add_u32 s30, s21, 101376
    s_waitcnt vmcnt(21)
    buffer_load_dwordx4 v8, s[8:11], s30 offen nt lds
    s_add_u32 m0, s26, 113664
    s_add_u32 s30, s21, 101888
    s_waitcnt vmcnt(21)
    buffer_load_dwordx4 v9, s[8:11], s30 offen nt lds
    s_add_u32 s20, s20, 1
    s_add_u32 s21, s20, s19
    s_and_b32 s21, s21, 15
    s_and_b32 s27, s20, 16
    s_lshl_b32 s29, s27, 15
    s_bfe_u32 s27, s21, 65536
    s_lshl_b32 s27, s27, 18
    s_or_b32 s29, s29, s27
    s_bfe_u32 s27, s21, 65537
    s_lshl_b32 s27, s27, 17
    s_or_b32 s29, s29, s27
    s_bfe_u32 s27, s21, 65538
    s_lshl_b32 s27, s27, 12
    s_or_b32 s29, s29, s27
    s_bfe_u32 s27, s21, 65539
    s_lshl_b32 s27, s27, 14
    s_or_b32 s29, s29, s27
    s_mov_b32 s21, s29
    s_cmp_lt_u32 s20, 32
    s_cbranch_scc1 L_ld
    s_branch L_drain
L_var21:
    s_add_u32 m0, s26, 0
    s_add_u32 s30, s21, 0
    s_waitcnt vmcnt(20)
    buffer_load_dwordx4 v4, s[4:7], s30 offen nt lds
    s_add_u32 m0, s26, 1024
    s_add_u32 s30, s21, 512
    s_waitcnt vmcnt(20)
    buffer_load_dwordx4 v5, s[4:7], s30 offen nt lds
    s_add_u32 m0, s26, 2048
    s_add_u32 s30, s21, 1024
    s_waitcnt vmcnt(20)
    buffer_load_dwordx4 v6, s[4:7], s30 offen nt lds
    s_add_u32 m0, s26, 3072
    s_add_u32 s30, s21, 1536
    s_waitcnt vmcnt(20)
    buffer_load_dwordx4 v7, s[4:7], s30 offen nt lds
    s_add_u32 m0, s26, 4096
    s_add_u32 s30, s21, 65536
    s_waitcnt vmcnt(20)
    buffer_load_dwordx4 v4, s[4:7], s30 offen nt lds
    s_add_u32 m0, s26, 5120
    s_add_u32 s30, s21, 66048
    s_waitcnt vmcnt(20)
    buffer_load_dwordx4 v5, s[4:7], s30 offen nt lds
    s_add_u32 m0, s26, 6144
    s_add_u32 s30, s21, 66560
    s_waitcnt vmcnt(20)
    buffer_load_dwordx4 v6, s[4:7], s30 offen nt lds
    s_add_u32 m0, s26, 7168
    s_add_u32 s30, s21, 67072
    s_waitcnt vmcnt(20)
    buffer_load_dwordx4 v7, s[4:7], s30 offen nt lds
    s_add_u32 m0, s26, 32768
    s_add_u32 s30, s21, 2048
    s_waitcnt vmcnt(20)
    buffer_load_dwordx4 v4, s[4:7], s30 offen nt lds
    s_add_u32 m0, s26, 33792
    s_add_u32 s30, s21, 2560
    s_waitcnt vmcnt(20)
    buffer_load_dwordx4 v5, s[4:7], s30 offen nt lds
    s_add_u32 m0, s26, 34816
    s_add_u32 s30, s21, 3072
    s_waitcnt vmcnt(20)
    buffer_load_dwordx4 v6, s[4:7], s30 offen nt lds
    s_add_u32 m0, s26, 35840
    s_add_u32 s30, s21, 3584
    s_waitcnt vmcnt(20)
    buffer_load_dwordx4 v7, s[4:7], s30 offen nt lds
    s_add_u32 m0, s26, 36864
    s_add_u32 s30, s21, 67584
    s_waitcnt vmcnt(20)
    buffer_load_dwordx4 v4, s[4:7], s30 offen nt lds
    s_add_u32 m0, s26, 37888
    s_add_u32 s30, s21, 68096
    s_waitcnt vmcnt(20)
    buffer_load_dwordx4 v5, s[4:7], s30 offen nt lds
    s_add_u32 m0, s26, 38912
    s_add_u32 s30, s21, 68608
    s_waitcnt vmcnt(20)
    buffer_load_dwordx4 v6, s[4:7], s30 offen nt lds
    s_add_u32 m0, s26, 39936
    s_add_u32 s30, s21, 69120
    s_waitcnt vmcnt(20)
    buffer_load_dwordx4 v7, s[4:7], s30 offen nt lds
    s_add_u32 m0, s26, 65536
    s_add_u32 s30, s21, 32768
    s_waitcnt vmcnt(20)
    buffer_load_dwordx4 v4, s[4:7], s30 offen nt lds
    s_add_u32 m0, s26, 66560
    s_add_u32 s30, s21, 33280
    s_waitcnt vmcnt(20)
    buffer_load_dwordx4 v5, s[4:7], s30 offen nt lds
    s_add_u32 m0, s26, 67584
    s_add_u32 s30, s21, 33792
    s_waitcnt vmcnt(20)
    buffer_load_dwordx4 v6, s[4:7], s30 offen nt lds
    s_add_u32 m0, s26, 68608
    s_add_u32 s30, s21, 34304
    s_waitcnt vmcnt(20)
    buffer_load_dwordx4 v7, s[4:7], s30 offen nt lds
    s_add_u32 m0, s26, 69632
    s_add_u32 s30, s21, 98304
    s_waitcnt vmcnt(20)
    s_add_i32 s27, s24, 0
    s_max_i32 s22, s22, s27
    v_mov_b32 v13, s22
    ds_write_b32 v12, v13
    buffer_load_dwordx4 v4, s[4:7], s30 offen nt lds
    s_add_u32 m0, s26, 70656
    s_add_u32 s30, s21, 98816
    s_waitcnt vmcnt(20)
    buffer_load_dwordx4 v5, s[4:7], s30 offen nt lds
    s_add_u32 m0, s26, 71680
    s_add_u32 s30, s21, 99328
    s_waitcnt vmcnt(20)
    buffer_load_dwordx4 v6, s[4:7], s30 offen nt lds
    s_add_u32 m0, s26, 72704
    s_add_u32 s30, s21, 99840
    s_waitcnt vmcnt(20)
    buffer_load_dwordx4 v7, s[4:7], s30 offen nt lds
    s_add_u32 m0, s26, 98304
    s_add_u32 s30, s21, 34816
    s_waitcnt vmcnt(20)
    buffer_load_dwordx4 v4, s[4:7], s30 offen nt lds
    s_add_u32 m0, s26, 99328
    s_add_u32 s30, s21, 35328
    s_waitcnt vmcnt(20)
    buffer_load_dwordx4 v5, s[4:7], s30 offen nt lds
    s_add_u32 m0, s26, 100352
    s_add_u32 s30, s21, 35840
    s_waitcnt vmcnt(20)
    buffer_load_dwordx4 v6, s[4:7], s30 offen nt lds
    s_add_u32 m0, s26, 101376
    s_add_u32 s30, s21, 36352
    s_waitcnt vmcnt(20)
    buffer_load_dwordx4 v7, s[4:7], s30 offen nt lds
    s_add_u32 m0, s26, 102400
    s_add_u32 s30, s21, 100352
    s_waitcnt vmcnt(20)
    buffer_load_dwordx4 v4, s[4:7], s30 offen nt lds
    s_add_u32 m0, s26, 103424
    s_add_u32 s30, s21, 100864
    s_waitcnt vmcnt(20)
    buffer_load_dwordx4 v5, s[4:7], s30 offen nt lds
    s_add_u32 m0, s26, 104448
    s_add_u32 s30, s21, 101376
    s_waitcnt vmcnt(20)
    buffer_load_dwordx4 v6, s[4:7], s30 offen nt lds
    s_add_u32 m0, s26, 105472
    s_add_u32 s30, s21, 101888
    s_waitcnt vmcnt(20)
    buffer_load_dwordx4 v7, s[4:7], s30 offen nt lds
    s_add_u32 m0, s26, 8192
    s_add_u32 s30, s21, 0
    s_waitcnt vmcnt(20)
    buffer_load_dwordx4 v8, s[8:11], s30 offen nt lds
    s_add_u32 m0, s26, 9216
    s_add_u32 s30, s21, 512
    s_waitcnt vmcnt(20)
    buffer_load_dwordx4 v9, s[8:11], s30 offen nt lds
    s_add_u32 m0, s26, 10240
    s_add_u32 s30, s21, 1024
    s_waitcnt vmcnt(20)
    buffer_load_dwordx4 v8, s[8:11], s30 offen nt lds
    s_add_u32 m0, s26, 11264
    s_add_u32 s30, s21, 1536
    s_waitcnt vmcnt(20)
    buffer_load_dwordx4 v9, s[8:11], s30 offen nt lds
    s_add_u32 m0, s26, 12288
    s_add_u32 s30, s21, 65536
    s_waitcnt vmcnt(20)
    buffer_load_dwordx4 v8, s[8:11], s30 offen nt lds
    s_add_u32 m0, s26, 13312
    s_add_u32 s30, s21, 66048
    s_waitcnt vmcnt(20)
    buffer_load_dwordx4 v9, s[8:11], s30 offen nt lds
    s_add_u32 m0, s26, 14336
    s_add_u32 s30, s21, 66560
    s_waitcnt vmcnt(20)
    buffer_load_dwordx4 v8, s[8:11], s30 offen nt lds
    s_add_u32 m0, s26, 15360
    s_add_u32 s30, s21, 67072
    s_waitcnt vmcnt(20)
    buffer_load_dwordx4 v9, s[8:11], s30 offen nt lds
    s_add_u32 m0, s26, 40960
    s_add_u32 s30, s21, 2048
    s_waitcnt vmcnt(20)
    buffer_load_dwordx4 v8, s[8:11], s30 offen nt lds
    s_add_u32 m0, s26, 41984
    s_add_u32 s30, s21, 2560
    s_waitcnt vmcnt(20)
    buffer_load_dwordx4 v9, s[8:11], s30 offen nt lds
    s_add_u32 m0, s26, 43008
    s_add_u32 s30, s21, 3072
    s_waitcnt vmcnt(20)
    buffer_load_dwordx4 v8, s[8:11], s30 offen nt lds
    s_add_u32 m0, s26, 44032
    s_add_u32 s30, s21, 3584
    s_waitcnt vmcnt(20)
    buffer_load_dwordx4 v9, s[8:11], s30 offen nt lds
    s_add_u32 m0, s26, 45056
    s_add_u32 s30, s21, 67584
    s_waitcnt vmcnt(20)
    buffer_load_dwordx4 v8, s[8:11], s30 offen nt lds
    s_add_u32 m0, s26, 46080
    s_add_u32 s30, s21, 68096
    s_waitcnt vmcnt(20)
    buffer_load_dwordx4 v9, s[8:11], s30 offen nt lds
    s_add_u32 m0, s26, 47104
    s_add_u32 s30, s21, 68608
    s_waitcnt vmcnt(20)
    buffer_load_dwordx4 v8, s[8:11], s30 offen nt lds
    s_add_u32 m0, s26, 48128
    s_add_u32 s30, s21, 69120
    s_waitcnt vmcnt(20)
    buffer_load_dwordx4 v9, s[8:11], s30 offen nt lds
    s_add_u32 m0, s26, 73728
    s_add_u32 s30, s21, 32768
    s_waitcnt vmcnt(20)
    buffer_load_dwordx4 v8, s[8:11], s30 offen nt lds
    s_add_u32 m0, s26, 74752
    s_add_u32 s30, s21, 33280
    s_waitcnt vmcnt(20)
    buffer_load_dwordx4 v9, s[8:11], s30 offen nt lds
    s_add_u32 m0, s26, 75776
    s_add_u32 s30, s21, 33792
    s_waitcnt vmcnt(20)
    buffer_load_dwordx4 v8, s[8:11], s30 offen nt lds
    s_add_u32 m0, s26, 76800
    s_add_u32 s30, s21, 34304
    s_waitcnt vmcnt(20)
    buffer_load_dwordx4 v9, s[8:11], s30 offen nt lds
    s_add_u32 m0, s26, 77824
    s_add_u32 s30, s21, 98304
    s_waitcnt vmcnt(20)
    s_add_i32 s27, s24, 1
    s_max_i32 s22, s22, s27
    v_mov_b32 v13, s22
    ds_write_b32 v12, v13
    buffer_load_dwordx4 v8, s[8:11], s30 offen nt lds
    s_add_u32 m0, s26, 78848
    s_add_u32 s30, s21, 98816
    s_waitcnt vmcnt(20)
    buffer_load_dwordx4 v9, s[8:11], s30 offen nt lds
    s_add_u32 m0, s26, 79872
    s_add_u32 s30, s21, 99328
    s_waitcnt vmcnt(20)
    buffer_load_dwordx4 v8, s[8:11], s30 offen nt lds
    s_add_u32 m0, s26, 80896
    s_add_u32 s30, s21, 99840
    s_waitcnt vmcnt(20)
    buffer_load_dwordx4 v9, s[8:11], s30 offen nt lds
    s_add_u32 m0, s26, 106496
    s_add_u32 s30, s21, 34816
    s_waitcnt vmcnt(20)
    ds_read_b32 v16, v15
    buffer_load_dwordx4 v8, s[8:11], s30 offen nt lds
    s_add_u32 m0, s26, 107520
    s_add_u32 s30, s21, 35328
    s_waitcnt vmcnt(20)
    buffer_load_dwordx4 v9, s[8:11], s30 offen nt lds
    s_add_u32 m0, s26, 108544
    s_add_u32 s30, s21, 35840
    s_waitcnt vmcnt(20)
    buffer_load_dwordx4 v8, s[8:11], s30 offen nt lds
    s_add_u32 m0, s26, 109568
    s_add_u32 s30, s21, 36352
    s_waitcnt vmcnt(20)
    buffer_load_dwordx4 v9, s[8:11], s30 offen nt lds
    s_add_u32 m0, s26, 110592
    s_add_u32 s30, s21, 100352
    s_waitcnt vmcnt(20)
    buffer_load_dwordx4 v8, s[8:11], s30 offen nt lds
    s_add_u32 m0, s26, 111616
    s_add_u32 s30, s21, 100864
    s_waitcnt vmcnt(20)
    buffer_load_dwordx4 v9, s[8:11], s30 offen nt lds
    s_add_u32 m0, s26, 112640
    s_add_u32 s30, s21, 101376
    s_waitcnt vmcnt(20)
    buffer_load_dwordx4 v8, s[8:11], s30 offen nt lds
    s_add_u32 m0, s26, 113664
    s_add_u32 s30, s21, 101888
    s_waitcnt vmcnt(20)
    buffer_load_dwordx4 v9, s[8:11], s30 offen nt lds
    s_add_u32 s20, s20, 1
    s_add_u32 s21, s20, s19
    s_and_b32 s21, s21, 15
    s_and_b32 s27, s20, 16
    s_lshl_b32 s29, s27, 15
    s_bfe_u32 s27, s21, 65536
    s_lshl_b32 s27, s27, 18
    s_or_b32 s29, s29, s27
    s_bfe_u32 s27, s21, 65537
    s_lshl_b32 s27, s27, 17
    s_or_b32 s29, s29, s27
    s_bfe_u32 s27, s21, 65538
    s_lshl_b32 s27, s27, 12
    s_or_b32 s29, s29, s27
    s_bfe_u32 s27, s21, 65539
    s_lshl_b32 s27, s27, 14
    s_or_b32 s29, s29, s27
    s_mov_b32 s21, s29
    s_cmp_lt_u32 s20, 32
    s_cbranch_scc1 L_ld
    s_branch L_drain
L_var20:
    s_add_u32 m0, s26, 0
    s_add_u32 s30, s21, 0
    s_waitcnt vmcnt(19)
    buffer_load_dwordx4 v4, s[4:7], s30 offen nt lds
    s_add_u32 m0, s26, 1024
    s_add_u32 s30, s21, 512
    s_waitcnt vmcnt(19)
    buffer_load_dwordx4 v5, s[4:7], s30 offen nt lds
    s_add_u32 m0, s26, 2048
    s_add_u32 s30, s21, 1024
    s_waitcnt vmcnt(19)
    buffer_load_dwordx4 v6, s[4:7], s30 offen nt lds
    s_add_u32 m0, s26, 3072
    s_add_u32 s30, s21, 1536
    s_waitcnt vmcnt(19)
    buffer_load_dwordx4 v7, s[4:7], s30 offen nt lds
    s_add_u32 m0, s26, 4096
    s_add_u32 s30, s21, 65536
    s_waitcnt vmcnt(19)
    buffer_load_dwordx4 v4, s[4:7], s30 offen nt lds
    s_add_u32 m0, s26, 5120
    s_add_u32 s30, s21, 66048
    s_waitcnt vmcnt(19)
    buffer_load_dwordx4 v5, s[4:7], s30 offen nt lds
    s_add_u32 m0, s26, 6144
    s_add_u32 s30, s21, 66560
    s_waitcnt vmcnt(19)
    buffer_load_dwordx4 v6, s[4:7], s30 offen nt lds
    s_add_u32 m0, s26, 7168
    s_add_u32 s30, s21, 67072
    s_waitcnt vmcnt(19)
    buffer_load_dwordx4 v7, s[4:7], s30 offen nt lds
    s_add_u32 m0, s26, 32768
    s_add_u32 s30, s21, 2048
    s_waitcnt vmcnt(19)
    buffer_load_dwordx4 v4, s[4:7], s30 offen nt lds
    s_add_u32 m0, s26, 33792
    s_add_u32 s30, s21, 2560
    s_waitcnt vmcnt(19)
    buffer_load_dwordx4 v5, s[4:7], s30 offen nt lds
    s_add_u32 m0, s26, 34816
    s_add_u32 s30, s21, 3072
    s_waitcnt vmcnt(19)
    buffer_load_dwordx4 v6, s[4:7], s30 offen nt lds
    s_add_u32 m0, s26, 35840
    s_add_u32 s30, s21, 3584
    s_waitcnt vmcnt(19)
    buffer_load_dwordx4 v7, s[4:7], s30 offen nt lds
    s_add_u32 m0, s26, 36864
    s_add_u32 s30, s21, 67584
    s_waitcnt vmcnt(19)
    buffer_load_dwordx4 v4, s[4:7], s30 offen nt lds
    s_add_u32 m0, s26, 37888
    s_add_u32 s30, s21, 68096
    s_waitcnt vmcnt(19)
    buffer_load_dwordx4 v5, s[4:7], s30 offen nt lds
    s_add_u32 m0, s26, 38912
    s_add_u32 s30, s21, 68608
    s_waitcnt vmcnt(19)
    buffer_load_dwordx4 v6, s[4:7], s30 offen nt lds
    s_add_u32 m0, s26, 39936
    s_add_u32 s30, s21, 69120
    s_waitcnt vmcnt(19)
    buffer_load_dwordx4 v7, s[4:7], s30 offen nt lds
    s_add_u32 m0, s26, 65536
    s_add_u32 s30, s21, 32768
    s_waitcnt vmcnt(19)
    buffer_load_dwordx4 v4, s[4:7], s30 offen nt lds
    s_add_u32 m0, s26, 66560
    s_add_u32 s30, s21, 33280
    s_waitcnt vmcnt(19)
    buffer_load_dwordx4 v5, s[4:7], s30 offen nt lds
    s_add_u32 m0, s26, 67584
    s_add_u32 s30, s21, 33792
    s_waitcnt vmcnt(19)
    buffer_load_dwordx4 v6, s[4:7], s30 offen nt lds
    s_add_u32 m0, s26, 68608
    s_add_u32 s30, s21, 34304
    s_waitcnt vmcnt(19)
    s_add_i32 s27, s24, 0
    s_max_i32 s22, s22, s27
    v_mov_b32 v13, s22
    ds_write_b32 v12, v13
    buffer_load_dwordx4 v7, s[4:7], s30 offen nt lds
    s_add_u32 m0, s26, 69632
    s_add_u32 s30, s21, 98304
    s_waitcnt vmcnt(19)
    buffer_load_dwordx4 v4, s[4:7], s30 offen nt lds
    s_add_u32 m0, s26, 70656
    s_add_u32 s30, s21, 98816
    s_waitcnt vmcnt(19)
    buffer_load_dwordx4 v5, s[4:7], s30 offen nt lds
    s_add_u32 m0, s26, 71680
    s_add_u32 s30, s21, 99328
    s_waitcnt vmcnt(19)
    buffer_load_dwordx4 v6, s[4:7], s30 offen nt lds
    s_add_u32 m0, s26, 72704
    s_add_u32 s30, s21, 99840
    s_waitcnt vmcnt(19)
    buffer_load_dwordx4 v7, s[4:7], s30 offen nt lds
    s_add_u32 m0, s26, 98304
    s_add_u32 s30, s21, 34816
    s_waitcnt vmcnt(19)
    buffer_load_dwordx4 v4, s[4:7], s30 offen nt lds
    s_add_u32 m0, s26, 99328
    s_add_u32 s30, s21, 35328
    s_waitcnt vmcnt(19)
    buffer_load_dwordx4 v5, s[4:7], s30 offen nt lds
    s_add_u32 m0, s26, 100352
    s_add_u32 s30, s21, 35840
    s_waitcnt vmcnt(19)
    buffer_load_dwordx4 v6, s[4:7], s30 offen nt lds
    s_add_u32 m0, s26, 101376
    s_add_u32 s30, s21, 36352
    s_waitcnt vmcnt(19)
    buffer_load_dwordx4 v7, s[4:7], s30 offen nt lds
    s_add_u32 m0, s26, 102400
    s_add_u32 s30, s21, 100352
    s_waitcnt vmcnt(19)
    buffer_load_dwordx4 v4, s[4:7], s30 offen nt lds
    s_add_u32 m0, s26, 103424
    s_add_u32 s30, s21, 100864
    s_waitcnt vmcnt(19)
    buffer_load_dwordx4 v5, s[4:7], s30 offen nt lds
    s_add_u32 m0, s26, 104448
    s_add_u32 s30, s21, 101376
    s_waitcnt vmcnt(19)
    buffer_load_dwordx4 v6, s[4:7], s30 offen nt lds
    s_add_u32 m0, s26, 105472
    s_add_u32 s30, s21, 101888
    s_waitcnt vmcnt(19)
    buffer_load_dwordx4 v7, s[4:7], s30 offen nt lds
    s_add_u32 m0, s26, 8192
    s_add_u32 s30, s21, 0
    s_waitcnt vmcnt(19)
    buffer_load_dwordx4 v8, s[8:11], s30 offen nt lds
    s_add_u32 m0, s26, 9216
    s_add_u32 s30, s21, 512
    s_waitcnt vmcnt(19)
    buffer_load_dwordx4 v9, s[8:11], s30 offen nt lds
    s_add_u32 m0, s26, 10240
    s_add_u32 s30, s21, 1024
    s_waitcnt vmcnt(19)
    buffer_load_dwordx4 v8, s[8:11], s30 offen nt lds
    s_add_u32 m0, s26, 11264
    s_add_u32 s30, s21, 1536
    s_waitcnt vmcnt(19)
    buffer_load_dwordx4 v9, s[8:11], s30 offen nt lds
    s_add_u32 m0, s26, 12288
    s_add_u32 s30, s21, 65536
    s_waitcnt vmcnt(19)
    buffer_load_dwordx4 v8, s[8:11], s30 offen nt lds
    s_add_u32 m0, s26, 13312
    s_add_u32 s30, s21, 66048
    s_waitcnt vmcnt(19)
    buffer_load_dwordx4 v9, s[8:11], s30 offen nt lds
    s_add_u32 m0, s26, 14336
    s_add_u32 s30, s21, 66560
    s_waitcnt vmcnt(19)
    buffer_load_dwordx4 v8, s[8:11], s30 offen nt lds
    s_add_u32 m0, s26, 15360
    s_add_u32 s30, s21, 67072
    s_waitcnt vmcnt(19)
    buffer_load_dwordx4 v9, s[8:11], s30 offen nt lds
    s_add_u32 m0, s26, 40960
    s_add_u32 s30, s21, 2048
    s_waitcnt vmcnt(19)
    buffer_load_dwordx4 v8, s[8:11], s30 offen nt lds
    s_add_u32 m0, s26, 41984
    s_add_u32 s30, s21, 2560
    s_waitcnt vmcnt(19)
    buffer_load_dwordx4 v9, s[8:11], s30 offen nt lds
    s_add_u32 m0, s26, 43008
    s_add_u32 s30, s21, 3072
    s_waitcnt vmcnt(19)
    buffer_load_dwordx4 v8, s[8:11], s30 offen nt lds
    s_add_u32 m0, s26, 44032
    s_add_u32 s30, s21, 3584
    s_waitcnt vmcnt(19)
    buffer_load_dwordx4 v9, s[8:11], s30 offen nt lds
    s_add_u32 m0, s26, 45056
    s_add_u32 s30, s21, 67584
    s_waitcnt vmcnt(19)
    buffer_load_dwordx4 v8, s[8:11], s30 offen nt lds
    s_add_u32 m0, s26, 46080
    s_add_u32 s30, s21, 68096
    s_waitcnt vmcnt(19)
    buffer_load_dwordx4 v9, s[8:11], s30 offen nt lds
    s_add_u32 m0, s26, 47104
    s_add_u32 s30, s21, 68608
    s_waitcnt vmcnt(19)
    buffer_load_dwordx4 v8, s[8:11], s30 offen nt lds
    s_add_u32 m0, s26, 48128
    s_add_u32 s30, s21, 69120
    s_waitcnt vmcnt(19)
    buffer_load_dwordx4 v9, s[8:11], s30 offen nt lds
    s_add_u32 m0, s26, 73728
    s_add_u32 s30, s21, 32768
    s_waitcnt vmcnt(19)
    buffer_load_dwordx4 v8, s[8:11], s30 offen nt lds
    s_add_u32 m0, s26, 74752
    s_add_u32 s30, s21, 33280
    s_waitcnt vmcnt(19)
    buffer_load_dwordx4 v9, s[8:11], s30 offen nt lds
    s_add_u32 m0, s26, 75776
    s_add_u32 s30, s21, 33792
    s_waitcnt vmcnt(19)
    buffer_load_dwordx4 v8, s[8:11], s30 offen nt lds
    s_add_u32 m0, s26, 76800
    s_add_u32 s30, s21, 34304
    s_waitcnt vmcnt(19)
    s_add_i32 s27, s24, 1
    s_max_i32 s22, s22, s27
    v_mov_b32 v13, s22
    ds_write_b32 v12, v13
    buffer_load_dwordx4 v9, s[8:11], s30 offen nt lds
    s_add_u32 m0, s26, 77824
    s_add_u32 s30, s21, 98304
    s_waitcnt vmcnt(19)
    buffer_load_dwordx4 v8, s[8:11], s30 offen nt lds
    s_add_u32 m0, s26, 78848
    s_add_u32 s30, s21, 98816
    s_waitcnt vmcnt(19)
    buffer_load_dwordx4 v9, s[8:11], s30 offen nt lds
    s_add_u32 m0, s26, 79872
    s_add_u32 s30, s21, 99328
    s_waitcnt vmcnt(19)
    buffer_load_dwordx4 v8, s[8:11], s30 offen nt lds
    s_add_u32 m0, s26, 80896
    s_add_u32 s30, s21, 99840
    s_waitcnt vmcnt(19)
    buffer_load_dwordx4 v9, s[8:11], s30 offen nt lds
    s_add_u32 m0, s26, 106496
    s_add_u32 s30, s21, 34816
    s_waitcnt vmcnt(19)
    ds_read_b32 v16, v15
    buffer_load_dwordx4 v8, s[8:11], s30 offen nt lds
    s_add_u32 m0, s26, 107520
    s_add_u32 s30, s21, 35328
    s_waitcnt vmcnt(19)
    buffer_load_dwordx4 v9, s[8:11], s30 offen nt lds
    s_add_u32 m0, s26, 108544
    s_add_u32 s30, s21, 35840
    s_waitcnt vmcnt(19)
    buffer_load_dwordx4 v8, s[8:11], s30 offen nt lds
    s_add_u32 m0, s26, 109568
    s_add_u32 s30, s21, 36352
    s_waitcnt vmcnt(19)
    buffer_load_dwordx4 v9, s[8:11], s30 offen nt lds
    s_add_u32 m0, s26, 110592
    s_add_u32 s30, s21, 100352
    s_waitcnt vmcnt(19)
    buffer_load_dwordx4 v8, s[8:11], s30 offen nt lds
    s_add_u32 m0, s26, 111616
    s_add_u32 s30, s21, 100864
    s_waitcnt vmcnt(19)
    buffer_load_dwordx4 v9, s[8:11], s30 offen nt lds
    s_add_u32 m0, s26, 112640
    s_add_u32 s30, s21, 101376
    s_waitcnt vmcnt(19)
    buffer_load_dwordx4 v8, s[8:11], s30 offen nt lds
    s_add_u32 m0, s26, 113664
    s_add_u32 s30, s21, 101888
    s_waitcnt vmcnt(19)
    buffer_load_dwordx4 v9, s[8:11], s30 offen nt lds
    s_add_u32 s20, s20, 1
    s_add_u32 s21, s20, s19
    s_and_b32 s21, s21, 15
    s_and_b32 s27, s20, 16
    s_lshl_b32 s29, s27, 15
    s_bfe_u32 s27, s21, 65536
    s_lshl_b32 s27, s27, 18
    s_or_b32 s29, s29, s27
    s_bfe_u32 s27, s21, 65537
    s_lshl_b32 s27, s27, 17
    s_or_b32 s29, s29, s27
    s_bfe_u32 s27, s21, 65538
    s_lshl_b32 s27, s27, 12
    s_or_b32 s29, s29, s27
    s_bfe_u32 s27, s21, 65539
    s_lshl_b32 s27, s27, 14
    s_or_b32 s29, s29, s27
    s_mov_b32 s21, s29
    s_cmp_lt_u32 s20, 32
    s_cbranch_scc1 L_ld
L_drain:
    s_waitcnt vmcnt(32)
    s_max_i32 s22, s22, 63
    v_mov_b32 v13, s22
    ds_write_b32 v12, v13
    s_waitcnt vmcnt(0)
    s_max_i32 s22, s22, 64
    v_mov_b32 v13, s22
    ds_write_b32 v12, v13
    s_waitcnt lgkmcnt(0)
    s_endpgm
L_ctl:
    s_waitcnt lgkmcnt(0)
    s_barrier
    s_add_u32 s4, s46, 0x200000
    s_addc_u32 s5, s47, 0
    v_mov_b32 v4, 159744
    v_mov_b32 v5, 162048
    s_lshr_b32 s26, s2, 3
    s_mul_i32 s33, s26, 128
    s_xor_b32 s26, s26, s2
    s_and_b32 s32, s26, 7
    s_mov_b32 s20, 4
    s_mov_b32 s44, 0
    s_mov_b32 s24, 14
    s_mov_b32 s27, 0x3d3851ec
    s_mov_b32 s28, 0x421bcccd
    v_mov_b32 v20, 0xbf666666
    v_mov_b32 v21, 0x41a00000
    s_mov_b32 s35, 800
L_ckl:
L_cka:
    ds_read_b32 v6, v4
    s_waitcnt lgkmcnt(0)
    v_readfirstlane_b32 s45, v6
    s_nop 1
    s_cmp_ge_i32 s45, s20
    s_cbranch_scc1 L_cka_go
    s_sub_u32 s59, s59, 1
    s_cbranch_scc1 L_done
    s_sleep 3
    s_branch L_cka
L_cka_go:
    s_memrealtime s[30:31]
    s_add_u32 s23, s20, 2
    s_waitcnt lgkmcnt(0)
    s_cmp_lg_u32 s32, 0
    s_cbranch_scc1 L_ck_nopub
    s_mov_b32 s34, s30
    s_atomic_swap s34, s[4:5], s33
L_ck_nopub:
L_ckb:
    ds_read_b32 v6, v4
    s_waitcnt lgkmcnt(0)
    v_readfirstlane_b32 s45, v6
    s_nop 1
    s_cmp_ge_i32 s45, s23
    s_cbranch_scc1 L_ckb_go
    s_sub_u32 s59, s59, 1
    s_cbranch_scc1 L_done
    s_sleep 3
    s_branch L_ckb
L_ckb_go:
    s_load_dword s64, s[4:5], 0
    s_load_dword s65, s[4:5], 128
    s_load_dword s66, s[4:5], 256
    s_load_dword s67, s[4:5], 384
    s_load_dword s68, s[4:5], 512
    s_load_dword s69, s[4:5], 640
    s_load_dword s70, s[4:5], 768
    s_load_dword s71, s[4:5], 896
    s_load_dword s72, s[4:5], 1024
    s_load_dword s73, s[4:5], 1152
    s_load_dword s74, s[4:5], 1280
    s_load_dword s75, s[4:5], 1408
    s_load_dword s76, s[4:5], 1536
    s_load_dword s77, s[4:5], 1664
    s_load_dword s78, s[4:5], 1792
    s_load_dword s79, s[4:5], 1920
    s_load_dword s80, s[4:5], 2048
    s_load_dword s81, s[4:5], 2176
    s_load_dword s82, s[4:5], 2304
    s_load_dword s83, s[4:5], 2432
    s_load_dword s84, s[4:5], 2560
    s_load_dword s85, s[4:5], 2688
    s_load_dword s86, s[4:5], 2816
    s_load_dword s87, s[4:5], 2944
    s_load_dword s88, s[4:5], 3072
    s_load_dword s89, s[4:5], 3200
    s_load_dword s90, s[4:5], 3328
    s_load_dword s91, s[4:5], 3456
    s_load_dword s92, s[4:5], 3584
    s_load_dword s93, s[4:5], 3712
    s_load_dword s94, s[4:5], 3840
    s_load_dword s95, s[4:5], 3968
    s_sub_u32 s22, 400, s30
    s_mov_b32 s25, 0
    s_mov_b32 s26, 0
    s_waitcnt lgkmcnt(0)
    s_add_u32 s64, s64, s22
    s_cmp_lt_u32 s64, s35
    s_cselect_b32 s64, s64, 0
    s_addc_u32 s26, s26, 0
    s_add_u32 s25, s25, s64
    s_add_u32 s65, s65, s22
    s_cmp_lt_u32 s65, s35
    s_cselect_b32 s65, s65, 0
    s_addc_u32 s26, s26, 0
    s_add_u32 s25, s25, s65
    s_add_u32 s66, s66, s22
    s_cmp_lt_u32 s66, s35
    s_cselect_b32 s66, s66, 0
    s_addc_u32 s26, s26, 0
    s_add_u32 s25, s25, s66
    s_add_u32 s67, s67, s22
    s_cmp_lt_u32 s67, s35
    s_cselect_b32 s67, s67, 0
    s_addc_u32 s26, s26, 0
    s_add_u32 s25, s25, s67
    s_add_u32 s68, s68, s22
    s_cmp_lt_u32 s68, s35
    s_cselect_b32 s68, s68, 0
    s_addc_u32 s26, s26, 0
    s_add_u32 s25, s25, s68
    s_add_u32 s69, s69, s22
    s_cmp_lt_u32 s69, s35
    s_cselect_b32 s69, s69, 0
    s_addc_u32 s26, s26, 0
    s_add_u32 s25, s25, s69
    s_add_u32 s70, s70, s22
    s_cmp_lt_u32 s70, s35
    s_cselect_b32 s70, s70, 0
    s_addc_u32 s26, s26, 0
    s_add_u32 s25, s25, s70
    s_add_u32 s71, s71, s22
    s_cmp_lt_u32 s71, s35
    s_cselect_b32 s71, s71, 0
    s_addc_u32 s26, s26, 0
    s_add_u32 s25, s25, s71
    s_add_u32 s72, s72, s22
    s_cmp_lt_u32 s72, s35
    s_cselect_b32 s72, s72, 0
    s_addc_u32 s26, s26, 0
    s_add_u32 s25, s25, s72
    s_add_u32 s73, s73, s22
    s_cmp_lt_u32 s73, s35
    s_cselect_b32 s73, s73, 0
    s_addc_u32 s26, s26, 0
    s_add_u32 s25, s25, s73
    s_add_u32 s74, s74, s22
    s_cmp_lt_u32 s74, s35
    s_cselect_b32 s74, s74, 0
    s_addc_u32 s26, s26, 0
    s_add_u32 s25, s25, s74
    s_add_u32 s75, s75, s22
    s_cmp_lt_u32 s75, s35
    s_cselect_b32 s75, s75, 0
    s_addc_u32 s26, s26, 0
    s_add_u32 s25, s25, s75
    s_add_u32 s76, s76, s22
    s_cmp_lt_u32 s76, s35
    s_cselect_b32 s76, s76, 0
    s_addc_u32 s26, s26, 0
    s_add_u32 s25, s25, s76
    s_add_u32 s77, s77, s22
    s_cmp_lt_u32 s77, s35
    s_cselect_b32 s77, s77, 0
    s_addc_u32 s26, s26, 0
    s_add_u32 s25, s25, s77
    s_add_u32 s78, s78, s22
    s_cmp_lt_u32 s78, s35
    s_cselect_b32 s78, s78, 0
    s_addc_u32 s26, s26, 0
    s_add_u32 s25, s25, s78
    s_add_u32 s79, s79, s22
    s_cmp_lt_u32 s79, s35
    s_cselect_b32 s79, s79, 0
    s_addc_u32 s26, s26, 0
    s_add_u32 s25, s25, s79
    s_add_u32 s80, s80, s22
    s_cmp_lt_u32 s80, s35
    s_cselect_b32 s80, s80, 0
    s_addc_u32 s26, s26, 0
    s_add_u32 s25, s25, s80
    s_add_u32 s81, s81, s22
    s_cmp_lt_u32 s81, s35
    s_cselect_b32 s81, s81, 0
    s_addc_u32 s26, s26, 0
    s_add_u32 s25, s25, s81
    s_add_u32 s82, s82, s22
    s_cmp_lt_u32 s82, s35
    s_cselect_b32 s82, s82, 0
    s_addc_u32 s26, s26, 0
    s_add_u32 s25, s25, s82
    s_add_u32 s83, s83, s22
    s_cmp_lt_u32 s83, s35
    s_cselect_b32 s83, s83, 0
    s_addc_u32 s26, s26, 0
    s_add_u32 s25, s25, s83
    s_add_u32 s84, s84, s22
    s_cmp_lt_u32 s84, s35
    s_cselect_b32 s84, s84, 0
    s_addc_u32 s26, s26, 0
    s_add_u32 s25, s25, s84
    s_add_u32 s85, s85, s22
    s_cmp_lt_u32 s85, s35
    s_cselect_b32 s85, s85, 0
    s_addc_u32 s26, s26, 0
    s_add_u32 s25, s25, s85
    s_add_u32 s86, s86, s22
    s_cmp_lt_u32 s86, s35
    s_cselect_b32 s86, s86, 0
    s_addc_u32 s26, s26, 0
    s_add_u32 s25, s25, s86
    s_add_u32 s87, s87, s22
    s_cmp_lt_u32 s87, s35
    s_cselect_b32 s87, s87, 0
    s_addc_u32 s26, s26, 0
    s_add_u32 s25, s25, s87
    s_add_u32 s88, s88, s22
    s_cmp_lt_u32 s88, s35
    s_cselect_b32 s88, s88, 0
    s_addc_u32 s26, s26, 0
    s_add_u32 s25, s25, s88
    s_add_u32 s89, s89, s22
    s_cmp_lt_u32 s89, s35
    s_cselect_b32 s89, s89, 0
    s_addc_u32 s26, s26, 0
    s_add_u32 s25, s25, s89
    s_add_u32 s90, s90, s22
    s_cmp_lt_u32 s90, s35
    s_cselect_b32 s90, s90, 0
    s_addc_u32 s26, s26, 0
    s_add_u32 s25, s25, s90
    s_add_u32 s91, s91, s22
    s_cmp_lt_u32 s91, s35
    s_cselect_b32 s91, s91, 0
    s_addc_u32 s26, s26, 0
    s_add_u32 s25, s25, s91
    s_add_u32 s92, s92, s22
    s_cmp_lt_u32 s92, s35
    s_cselect_b32 s92, s92, 0
    s_addc_u32 s26, s26, 0
    s_add_u32 s25, s25, s92
    s_add_u32 s93, s93, s22
    s_cmp_lt_u32 s93, s35
    s_cselect_b32 s93, s93, 0
    s_addc_u32 s26, s26, 0
    s_add_u32 s25, s25, s93
    s_add_u32 s94, s94, s22
    s_cmp_lt_u32 s94, s35
    s_cselect_b32 s94, s94, 0
    s_addc_u32 s26, s26, 0
    s_add_u32 s25, s25, s94
    s_add_u32 s95, s95, s22
    s_cmp_lt_u32 s95, s35
    s_cselect_b32 s95, s95, 0
    s_addc_u32 s26, s26, 0
    s_add_u32 s25, s25, s95
    s_cmp_lt_u32 s26, 4
    s_cbranch_scc1 L_ck_dbg
    s_mul_i32 s22, s26, 400
    s_sub_i32 s25, s22, s25
    v_cvt_f32_i32 v10, s25
    v_cvt_f32_u32 v13, s26
    v_rcp_f32 v13, v13
    s_nop 0
    v_mul_f32 v10, v10, v13
    v_mul_f32 v10, s27, v10
    v_add_f32 v10, s28, v10
    v_fma_f32 v10, v20, v21, v10
    v_cvt_i32_f32 v10, v10
    v_max_i32 v10, 20, v10
    v_min_i32 v10, 26, v10
    ds_write_b32 v5, v10
    v_cvt_f32_i32 v21, v10
L_ck_dbg:
    s_add_u32 s20, s20, 4
    s_add_u32 s44, s44, 4
    s_add_u32 s4, s4, 4096
    s_addc_u32 s5, s5, 0
    s_sub_u32 s24, s24, 1
    s_cmp_lg_u32 s24, 0
    s_cbranch_scc1 L_ckl
    s_waitcnt vmcnt(0) lgkmcnt(0)
    s_endpgm
L_consumer:
    s_sub_u32 s25, s25, 1
    s_lshl_b32 s26, s25, 15
    v_lshlrev_b32 v22, 4, v2
    v_lshl_add_u32 v23, v1, 8, v22
    v_and_b32 v3, 7, v1
    v_lshl_add_u32 v22, v3, 8, v22
    s_waitcnt lgkmcnt(0)
    s_barrier
    s_add_u32 s12, s32, s63
    s_addc_u32 s13, s33, 0
    s_and_b32 s13, s13, 0xffff
    s_mov_b32 s14, 4096
    s_mov_b32 s15, 0x20000
    s_mov_b32 s21, 2048
    s_mov_b32 s16, s38
    s_and_b32 s17, s39, 0xffff
    s_mov_b32 s18, 4096
    s_mov_b32 s19, 0x20000
    buffer_load_dwordx4 v[24:27], v23, s[16:19], 0 offen offset:0
    buffer_load_dwordx4 v[28:31], v23, s[16:19], 0 offen offset:64
    buffer_load_dwordx4 v[32:35], v23, s[16:19], 0 offen offset:128
    buffer_load_dwordx4 v[36:39], v23, s[16:19], 0 offen offset:192
    s_mul_i32 s21, s21, s25
    v_mov_b32 v179, v22
    v_lshlrev_b32 v22, 8, v1
    v_add_u32 v22, s26, v22
    v_xor_b32 v3, v1, v2
    v_xor_b32 v23, 0, v3
    v_lshl_add_u32 v10, v23, 4, v22
    v_xor_b32 v23, 4, v3
    v_lshl_add_u32 v11, v23, 4, v22
    v_xor_b32 v23, 8, v3
    v_lshl_add_u32 v12, v23, 4, v22
    v_xor_b32 v23, 12, v3
    v_lshl_add_u32 v13, v23, 4, v22
    v_lshrrev_b32 v3, 2, v0
    v_lshlrev_b32 v22, 8, v3
    v_add_u32 v22, s26, v22
    v_and_b32 v23, 3, v0
    v_lshl_add_u32 v22, v23, 3, v22
    v_add_u32 v22, 8192, v22
    v_and_b32 v3, 7, v3
    s_lshl_b32 s44, s25, 1
    s_add_u32 s45, s44, 0
    s_and_b32 s45, s45, 7
    v_xor_b32 v23, s45, v3
    v_lshl_add_u32 v14, v23, 5, v22
    s_add_u32 s45, s44, 1
    s_and_b32 s45, s45, 7
    v_xor_b32 v23, s45, v3
    v_lshl_add_u32 v15, v23, 5, v22
    s_add_u32 s45, s44, 2
    s_and_b32 s45, s45, 7
    v_xor_b32 v23, s45, v3
    v_lshl_add_u32 v16, v23, 5, v22
    s_add_u32 s45, s44, 3
    s_and_b32 s45, s45, 7
    v_xor_b32 v23, s45, v3
    v_lshl_add_u32 v17, v23, 5, v22
    s_add_u32 s45, s44, 4
    s_and_b32 s45, s45, 7
    v_xor_b32 v23, s45, v3
    v_lshl_add_u32 v18, v23, 5, v22
    s_add_u32 s45, s44, 5
    s_and_b32 s45, s45, 7
    v_xor_b32 v23, s45, v3
    v_lshl_add_u32 v19, v23, 5, v22
    s_add_u32 s45, s44, 6
    s_and_b32 s45, s45, 7
    v_xor_b32 v23, s45, v3
    v_lshl_add_u32 v20, v23, 5, v22
    s_add_u32 s45, s44, 7
    s_and_b32 s45, s45, 7
    v_xor_b32 v23, s45, v3
    v_lshl_add_u32 v21, v23, 5, v22
    v_lshlrev_b32 v3, 4, v0
    s_add_u32 s45, s25, 1
    s_and_b32 s45, s45, 3
    s_mul_i32 s45, s45, 6144
    s_add_u32 s45, s45, 131072
    v_add_u32 v192, s45, v3
    s_add_u32 s45, s25, 2
    s_and_b32 s45, s45, 3
    s_mul_i32 s45, s45, 6144
    s_add_u32 s45, s45, 133120
    v_add_u32 v193, s45, v3
    s_add_u32 s45, s25, 3
    s_and_b32 s45, s45, 3
    s_mul_i32 s45, s45, 6144
    s_add_u32 s45, s45, 135168
    v_add_u32 v194, s45, v3
    s_mul_i32 s45, s25, 6144
    s_add_u32 s45, s45, 131072
    v_add_u32 v195, s45, v3
    s_lshl_b32 s45, s25, 10
    s_add_u32 s45, s45, 155648
    v_add_u32 v196, s45, v3
    v_add_u32 v197, 155648, v3
    v_lshlrev_b32 v3, 2, v0
    s_lshl_b32 s45, s25, 8
    s_add_u32 s45, s45, 160000
    v_add_u32 v198, s45, v3
    v_and_b32 v3, 3, v0
    v_lshlrev_b32 v3, 8, v3
    v_add_u32 v199, 161024, v3
    v_mov_b32 v23, 159744
    s_mov_b32 s27, 0xffff0000
    s_mov_b32 s28, 0x3e9837f0
    s_mov_b32 s29, 0x3e9837f0
    s_mov_b32 s30, 0x3fb8aa3b
    s_mov_b32 s31, 0x3e800000
    v_mov_b32 v180, 0.5
    v_mov_b32 v184, 0x3f803f80
    v_mov_b32 v185, 0x3f803f80
    v_mov_b32 v186, 0x3f803f80
    v_mov_b32 v187, 0x3f803f80
    v_mov_b32 v188, 0x358637bd
    s_waitcnt vmcnt(0)
    v_lshlrev_b32 v178, 3, v0
    v_add_u32 v178, 162304, v178
    s_cmp_ge_u32 s25, 2
    s_cbranch_scc1 L_noq2
L_pf1:
    ds_read_b32 v22, v23
    s_waitcnt lgkmcnt(0)
    v_readfirstlane_b32 s45, v22
    s_nop 1
    s_cmp_ge_i32 s45, 1
    s_cbranch_scc1 L_pg2
    s_sub_u32 s59, s59, 1
    s_cbranch_scc1 L_done
    s_sleep 1
    s_branch L_pf1
L_pg2:
    buffer_load_dwordx4 v[72:75], v179, s[12:15], s21 offen offset:0 nt
    buffer_load_dwordx4 v[76:79], v179, s[12:15], s21 offen offset:64 nt
    buffer_load_dwordx4 v[80:83], v179, s[12:15], s21 offen offset:128 nt
    buffer_load_dwordx4 v[84:87], v179, s[12:15], s21 offen offset:192 nt
    s_waitcnt vmcnt(0)
    v_lshlrev_b32 v156, 16, v72
    v_and_b32 v157, s27, v72
    v_pk_mul_f32 v[156:157], v[156:157], s[28:29]
    v_cvt_pk_bf16_f32 v72, v156, v157
    v_dot2_f32_bf16 v190, v72, v72, 0
    v_lshlrev_b32 v158, 16, v73
    v_and_b32 v159, s27, v73
    v_pk_mul_f32 v[158:159], v[158:159], s[28:29]
    v_cvt_pk_bf16_f32 v73, v158, v159
    v_dot2_f32_bf16 v190, v73, v73, v190
    v_lshlrev_b32 v160, 16, v74
    v_and_b32 v161, s27, v74
    v_pk_mul_f32 v[160:161], v[160:161], s[28:29]
    v_cvt_pk_bf16_f32 v74, v160, v161
    v_dot2_f32_bf16 v190, v74, v74, v190
    v_lshlrev_b32 v162, 16, v75
    v_and_b32 v163, s27, v75
    v_pk_mul_f32 v[162:163], v[162:163], s[28:29]
    v_cvt_pk_bf16_f32 v75, v162, v163
    v_dot2_f32_bf16 v190, v75, v75, v190
    v_lshlrev_b32 v156, 16, v76
    v_and_b32 v157, s27, v76
    v_pk_mul_f32 v[156:157], v[156:157], s[28:29]
    v_cvt_pk_bf16_f32 v76, v156, v157
    v_dot2_f32_bf16 v190, v76, v76, v190
    v_lshlrev_b32 v158, 16, v77
    v_and_b32 v159, s27, v77
    v_pk_mul_f32 v[158:159], v[158:159], s[28:29]
    v_cvt_pk_bf16_f32 v77, v158, v159
    v_dot2_f32_bf16 v190, v77, v77, v190
    v_lshlrev_b32 v160, 16, v78
    v_and_b32 v161, s27, v78
    v_pk_mul_f32 v[160:161], v[160:161], s[28:29]
    v_cvt_pk_bf16_f32 v78, v160, v161
    v_dot2_f32_bf16 v190, v78, v78, v190
    v_lshlrev_b32 v162, 16, v79
    v_and_b32 v163, s27, v79
    v_pk_mul_f32 v[162:163], v[162:163], s[28:29]
    v_cvt_pk_bf16_f32 v79, v162, v163
    v_dot2_f32_bf16 v190, v79, v79, v190
    v_lshlrev_b32 v156, 16, v80
    v_and_b32 v157, s27, v80
    v_pk_mul_f32 v[156:157], v[156:157], s[28:29]
    v_cvt_pk_bf16_f32 v80, v156, v157
    v_dot2_f32_bf16 v190, v80, v80, v190
    v_lshlrev_b32 v158, 16, v81
    v_and_b32 v159, s27, v81
    v_pk_mul_f32 v[158:159], v[158:159], s[28:29]
    v_cvt_pk_bf16_f32 v81, v158, v159
    v_dot2_f32_bf16 v190, v81, v81, v190
    v_lshlrev_b32 v160, 16, v82
    v_and_b32 v161, s27, v82
    v_pk_mul_f32 v[160:161], v[160:161], s[28:29]
    v_cvt_pk_bf16_f32 v82, v160, v161
    v_dot2_f32_bf16 v190, v82, v82, v190
    v_lshlrev_b32 v162, 16, v83
    v_and_b32 v163, s27, v83
    v_pk_mul_f32 v[162:163], v[162:163], s[28:29]
    v_cvt_pk_bf16_f32 v83, v162, v163
    v_dot2_f32_bf16 v190, v83, v83, v190
    v_lshlrev_b32 v156, 16, v84
    v_and_b32 v157, s27, v84
    v_pk_mul_f32 v[156:157], v[156:157], s[28:29]
    v_cvt_pk_bf16_f32 v84, v156, v157
    v_dot2_f32_bf16 v190, v84, v84, v190
    v_lshlrev_b32 v158, 16, v85
    v_and_b32 v159, s27, v85
    v_pk_mul_f32 v[158:159], v[158:159], s[28:29]
    v_cvt_pk_bf16_f32 v85, v158, v159
    v_dot2_f32_bf16 v190, v85, v85, v190
    v_lshlrev_b32 v160, 16, v86
    v_and_b32 v161, s27, v86
    v_pk_mul_f32 v[160:161], v[160:161], s[28:29]
    v_cvt_pk_bf16_f32 v86, v160, v161
    v_dot2_f32_bf16 v190, v86, v86, v190
    v_lshlrev_b32 v162, 16, v87
    v_and_b32 v163, s27, v87
    v_pk_mul_f32 v[162:163], v[162:163], s[28:29]
    v_cvt_pk_bf16_f32 v87, v162, v163
    v_dot2_f32_bf16 v190, v87, v87, v190
    s_nop 2
    v_mfma_f32_16x16x32_bf16 v[140:143], v[24:27], v[72:75], 0
    v_mfma_f32_16x16x32_bf16 v[140:143], v[28:31], v[76:79], v[140:143]
    v_mfma_f32_16x16x32_bf16 v[140:143], v[32:35], v[80:83], v[140:143]
    v_mfma_f32_16x16x32_bf16 v[140:143], v[36:39], v[84:87], v[140:143]
    v_mfma_f32_16x16x4_f32 v[148:151], v180, v190, 0
    s_nop 7
    s_nop 7
    v_cvt_pk_bf16_f32 v164, v140, v141
    v_cvt_pk_bf16_f32 v165, v142, v143
    v_cvt_pk_bf16_f32 v166, v148, v149
    v_cvt_pk_bf16_f32 v167, v150, v151
    v_lshlrev_b32 v140, 16, v164
    v_and_b32 v141, s27, v164
    v_lshlrev_b32 v142, 16, v165
    v_and_b32 v143, s27, v165
    v_lshlrev_b32 v148, 16, v166
    v_and_b32 v149, s27, v166
    v_lshlrev_b32 v150, 16, v167
    v_and_b32 v151, s27, v167
    v_sub_f32 v140, v140, v148
    v_sub_f32 v141, v141, v149
    v_sub_f32 v142, v142, v150
    v_sub_f32 v143, v143, v151
    v_cvt_pk_bf16_f32 v164, v140, v141
    v_cvt_pk_bf16_f32 v165, v142, v143
    v_lshlrev_b32 v140, 16, v164
    v_and_b32 v141, s27, v164
    v_lshlrev_b32 v142, 16, v165
    v_and_b32 v143, s27, v165
    v_mul_f32 v140, s30, v140
    v_mul_f32 v141, s30, v141
    v_mul_f32 v142, s30, v142
    v_mul_f32 v143, s30, v143
    v_exp_f32 v140, v140
    v_exp_f32 v141, v141
    v_exp_f32 v142, v142
    v_exp_f32 v143, v143
    s_nop 0
    v_cvt_pk_bf16_f32 v164, v140, v141
    v_cvt_pk_bf16_f32 v165, v142, v143
    v_lshlrev_b32 v140, 16, v164
    v_and_b32 v141, s27, v164
    v_lshlrev_b32 v142, 16, v165
    v_and_b32 v143, s27, v165
    v_fma_f32 v140, v140, s31, v188
    v_fma_f32 v141, v141, s31, v188
    v_fma_f32 v142, v142, s31, v188
    v_fma_f32 v143, v143, s31, v188
    v_cvt_pk_bf16_f32 v176, v140, v141
    v_cvt_pk_bf16_f32 v177, v142, v143
    s_lshl_b32 s44, s25, 9
    v_add_u32 v3, s44, v178
    ds_write_b64 v3, v[176:177]
L_noq2:
    s_add_u32 s12, s40, s63
    s_addc_u32 s13, s41, 0
    s_and_b32 s13, s13, 0xffff
    s_mov_b32 s14, 2048
    s_mov_b32 s20, 1
    s_mov_b32 s22, 0
    s_mov_b32 s23, 1
L_bh:
    v_mov_b32 v104, 0
    v_mov_b32 v105, 0
    v_mov_b32 v106, 0
    v_mov_b32 v107, 0
    v_mov_b32 v108, 0
    v_mov_b32 v109, 0
    v_mov_b32 v110, 0
    v_mov_b32 v111, 0
    v_mov_b32 v112, 0
    v_mov_b32 v113, 0
    v_mov_b32 v114, 0
    v_mov_b32 v115, 0
    v_mov_b32 v116, 0
    v_mov_b32 v117, 0
    v_mov_b32 v118, 0
    v_mov_b32 v119, 0
    v_mov_b32 v120, 0
    v_mov_b32 v121, 0
    v_mov_b32 v122, 0
    v_mov_b32 v123, 0
    v_mov_b32 v124, 0
    v_mov_b32 v125, 0
    v_mov_b32 v126, 0
    v_mov_b32 v127, 0
    v_mov_b32 v128, 0
    v_mov_b32 v129, 0
    v_mov_b32 v130, 0
    v_mov_b32 v131, 0
    v_mov_b32 v132, 0
    v_mov_b32 v133, 0
    v_mov_b32 v134, 0
    v_mov_b32 v135, 0
    v_mov_b32 v136, 0
    v_mov_b32 v137, 0
    v_mov_b32 v138, 0
    v_mov_b32 v139, 0
    s_mov_b32 s24, 16
.p2align 6
L_tile:
L_pf3:
    ds_read_b32 v22, v23
    s_waitcnt lgkmcnt(0)
    v_readfirstlane_b32 s45, v22
    s_nop 1
    s_cmp_ge_i32 s45, s20
    s_cbranch_scc1 L_pg4
    s_sub_u32 s59, s59, 1
    s_cbranch_scc1 L_done
    s_sleep 1
    s_branch L_pf3
L_pg4:
    ds_read_b128 v[40:43], v10 offset:0
    ds_read_b128 v[44:47], v11 offset:0
    ds_read_b128 v[48:51], v12 offset:0
    ds_read_b128 v[52:55], v13 offset:0
    ds_read_b128 v[56:59], v10 offset:4096
    ds_read_b128 v[60:63], v11 offset:4096
    ds_read_b128 v[64:67], v12 offset:4096
    ds_read_b128 v[68:71], v13 offset:4096
    s_add_u32 s21, s20, 1
    s_waitcnt lgkmcnt(0)
    v_lshlrev_b32 v156, 16, v40
    v_and_b32 v157, s27, v40
    v_pk_mul_f32 v[156:157], v[156:157], s[28:29]
    v_cvt_pk_bf16_f32 v40, v156, v157
    v_dot2_f32_bf16 v190, v40, v40, 0
    v_lshlrev_b32 v158, 16, v41
    v_and_b32 v159, s27, v41
    v_pk_mul_f32 v[158:159], v[158:159], s[28:29]
    v_cvt_pk_bf16_f32 v41, v158, v159
    v_dot2_f32_bf16 v190, v41, v41, v190
    v_lshlrev_b32 v160, 16, v42
    v_and_b32 v161, s27, v42
    v_pk_mul_f32 v[160:161], v[160:161], s[28:29]
    v_cvt_pk_bf16_f32 v42, v160, v161
    v_dot2_f32_bf16 v190, v42, v42, v190
    v_lshlrev_b32 v162, 16, v43
    v_and_b32 v163, s27, v43
    v_pk_mul_f32 v[162:163], v[162:163], s[28:29]
    v_cvt_pk_bf16_f32 v43, v162, v163
    v_dot2_f32_bf16 v190, v43, v43, v190
    v_lshlrev_b32 v156, 16, v44
    v_and_b32 v157, s27, v44
    v_pk_mul_f32 v[156:157], v[156:157], s[28:29]
    v_cvt_pk_bf16_f32 v44, v156, v157
    v_dot2_f32_bf16 v190, v44, v44, v190
    v_lshlrev_b32 v158, 16, v45
    v_and_b32 v159, s27, v45
    v_pk_mul_f32 v[158:159], v[158:159], s[28:29]
    v_cvt_pk_bf16_f32 v45, v158, v159
    v_dot2_f32_bf16 v190, v45, v45, v190
    v_lshlrev_b32 v160, 16, v46
    v_and_b32 v161, s27, v46
    v_pk_mul_f32 v[160:161], v[160:161], s[28:29]
    v_cvt_pk_bf16_f32 v46, v160, v161
    v_dot2_f32_bf16 v190, v46, v46, v190
    v_lshlrev_b32 v162, 16, v47
    v_and_b32 v163, s27, v47
    v_pk_mul_f32 v[162:163], v[162:163], s[28:29]
    v_cvt_pk_bf16_f32 v47, v162, v163
    v_dot2_f32_bf16 v190, v47, v47, v190
    v_lshlrev_b32 v156, 16, v48
    v_and_b32 v157, s27, v48
    v_pk_mul_f32 v[156:157], v[156:157], s[28:29]
    v_cvt_pk_bf16_f32 v48, v156, v157
    v_dot2_f32_bf16 v190, v48, v48, v190
    v_lshlrev_b32 v158, 16, v49
    v_and_b32 v159, s27, v49
    v_pk_mul_f32 v[158:159], v[158:159], s[28:29]
    v_cvt_pk_bf16_f32 v49, v158, v159
    v_dot2_f32_bf16 v190, v49, v49, v190
    v_lshlrev_b32 v160, 16, v50
    v_and_b32 v161, s27, v50
    v_pk_mul_f32 v[160:161], v[160:161], s[28:29]
    v_cvt_pk_bf16_f32 v50, v160, v161
    v_dot2_f32_bf16 v190, v50, v50, v190
    v_lshlrev_b32 v162, 16, v51
    v_and_b32 v163, s27, v51
    v_pk_mul_f32 v[162:163], v[162:163], s[28:29]
    v_cvt_pk_bf16_f32 v51, v162, v163
    v_dot2_f32_bf16 v190, v51, v51, v190
    v_lshlrev_b32 v156, 16, v52
    v_and_b32 v157, s27, v52
    v_pk_mul_f32 v[156:157], v[156:157], s[28:29]
    v_cvt_pk_bf16_f32 v52, v156, v157
    v_dot2_f32_bf16 v190, v52, v52, v190
    v_lshlrev_b32 v158, 16, v53
    v_and_b32 v159, s27, v53
    v_pk_mul_f32 v[158:159], v[158:159], s[28:29]
    v_cvt_pk_bf16_f32 v53, v158, v159
    v_dot2_f32_bf16 v190, v53, v53, v190
    v_lshlrev_b32 v160, 16, v54
    v_and_b32 v161, s27, v54
    v_pk_mul_f32 v[160:161], v[160:161], s[28:29]
    v_cvt_pk_bf16_f32 v54, v160, v161
    v_dot2_f32_bf16 v190, v54, v54, v190
    v_lshlrev_b32 v162, 16, v55
    v_and_b32 v163, s27, v55
    v_pk_mul_f32 v[162:163], v[162:163], s[28:29]
    v_cvt_pk_bf16_f32 v55, v162, v163
    v_dot2_f32_bf16 v190, v55, v55, v190
    v_lshlrev_b32 v156, 16, v56
    v_and_b32 v157, s27, v56
    v_pk_mul_f32 v[156:157], v[156:157], s[28:29]
    v_cvt_pk_bf16_f32 v56, v156, v157
    v_dot2_f32_bf16 v191, v56, v56, 0
    v_lshlrev_b32 v158, 16, v57
    v_and_b32 v159, s27, v57
    v_pk_mul_f32 v[158:159], v[158:159], s[28:29]
    v_cvt_pk_bf16_f32 v57, v158, v159
    v_dot2_f32_bf16 v191, v57, v57, v191
    v_lshlrev_b32 v160, 16, v58
    v_and_b32 v161, s27, v58
    v_pk_mul_f32 v[160:161], v[160:161], s[28:29]
    v_cvt_pk_bf16_f32 v58, v160, v161
    v_dot2_f32_bf16 v191, v58, v58, v191
    v_lshlrev_b32 v162, 16, v59
    v_and_b32 v163, s27, v59
    v_pk_mul_f32 v[162:163], v[162:163], s[28:29]
    v_cvt_pk_bf16_f32 v59, v162, v163
    v_dot2_f32_bf16 v191, v59, v59, v191
    v_lshlrev_b32 v156, 16, v60
    v_and_b32 v157, s27, v60
    v_pk_mul_f32 v[156:157], v[156:157], s[28:29]
    v_cvt_pk_bf16_f32 v60, v156, v157
    v_dot2_f32_bf16 v191, v60, v60, v191
    v_lshlrev_b32 v158, 16, v61
    v_and_b32 v159, s27, v61
    v_pk_mul_f32 v[158:159], v[158:159], s[28:29]
    v_cvt_pk_bf16_f32 v61, v158, v159
    v_dot2_f32_bf16 v191, v61, v61, v191
    v_lshlrev_b32 v160, 16, v62
    v_and_b32 v161, s27, v62
    v_pk_mul_f32 v[160:161], v[160:161], s[28:29]
    v_cvt_pk_bf16_f32 v62, v160, v161
    v_dot2_f32_bf16 v191, v62, v62, v191
    v_lshlrev_b32 v162, 16, v63
    v_and_b32 v163, s27, v63
    v_pk_mul_f32 v[162:163], v[162:163], s[28:29]
    v_cvt_pk_bf16_f32 v63, v162, v163
    v_dot2_f32_bf16 v191, v63, v63, v191
    v_lshlrev_b32 v156, 16, v64
    v_and_b32 v157, s27, v64
    v_pk_mul_f32 v[156:157], v[156:157], s[28:29]
    v_cvt_pk_bf16_f32 v64, v156, v157
    v_dot2_f32_bf16 v191, v64, v64, v191
    v_lshlrev_b32 v158, 16, v65
    v_and_b32 v159, s27, v65
    v_pk_mul_f32 v[158:159], v[158:159], s[28:29]
    v_cvt_pk_bf16_f32 v65, v158, v159
    v_dot2_f32_bf16 v191, v65, v65, v191
    v_lshlrev_b32 v160, 16, v66
    v_and_b32 v161, s27, v66
    v_pk_mul_f32 v[160:161], v[160:161], s[28:29]
    v_cvt_pk_bf16_f32 v66, v160, v161
    v_dot2_f32_bf16 v191, v66, v66, v191
    v_lshlrev_b32 v162, 16, v67
    v_and_b32 v163, s27, v67
    v_pk_mul_f32 v[162:163], v[162:163], s[28:29]
    v_cvt_pk_bf16_f32 v67, v162, v163
    v_dot2_f32_bf16 v191, v67, v67, v191
    v_lshlrev_b32 v156, 16, v68
    v_and_b32 v157, s27, v68
    v_pk_mul_f32 v[156:157], v[156:157], s[28:29]
    v_cvt_pk_bf16_f32 v68, v156, v157
    v_dot2_f32_bf16 v191, v68, v68, v191
    v_lshlrev_b32 v158, 16, v69
    v_and_b32 v159, s27, v69
    v_pk_mul_f32 v[158:159], v[158:159], s[28:29]
    v_cvt_pk_bf16_f32 v69, v158, v159
    v_dot2_f32_bf16 v191, v69, v69, v191
    v_lshlrev_b32 v160, 16, v70
    v_and_b32 v161, s27, v70
    v_pk_mul_f32 v[160:161], v[160:161], s[28:29]
    v_cvt_pk_bf16_f32 v70, v160, v161
    v_dot2_f32_bf16 v191, v70, v70, v191
    v_lshlrev_b32 v162, 16, v71
    v_and_b32 v163, s27, v71
    v_pk_mul_f32 v[162:163], v[162:163], s[28:29]
    v_cvt_pk_bf16_f32 v71, v162, v163
    v_dot2_f32_bf16 v191, v71, v71, v191
    s_nop 2
    v_mfma_f32_16x16x32_bf16 v[140:143], v[40:43], v[24:27], 0
    v_mfma_f32_16x16x32_bf16 v[140:143], v[44:47], v[28:31], v[140:143]
    v_mfma_f32_16x16x32_bf16 v[140:143], v[48:51], v[32:35], v[140:143]
    v_mfma_f32_16x16x32_bf16 v[140:143], v[52:55], v[36:39], v[140:143]
    v_mfma_f32_16x16x4_f32 v[148:151], v190, v180, 0
    v_mfma_f32_16x16x32_bf16 v[144:147], v[56:59], v[24:27], 0
    v_mfma_f32_16x16x32_bf16 v[144:147], v[60:63], v[28:31], v[144:147]
    v_mfma_f32_16x16x32_bf16 v[144:147], v[64:67], v[32:35], v[144:147]
    v_mfma_f32_16x16x32_bf16 v[144:147], v[68:71], v[36:39], v[144:147]
    v_mfma_f32_16x16x4_f32 v[152:155], v191, v180, 0
    s_nop 7
    s_nop 7
    v_cvt_pk_bf16_f32 v164, v140, v141
    v_cvt_pk_bf16_f32 v165, v142, v143
    v_cvt_pk_bf16_f32 v166, v148, v149
    v_cvt_pk_bf16_f32 v167, v150, v151
    v_lshlrev_b32 v140, 16, v164
    v_and_b32 v141, s27, v164
    v_lshlrev_b32 v142, 16, v165
    v_and_b32 v143, s27, v165
    v_lshlrev_b32 v148, 16, v166
    v_and_b32 v149, s27, v166
    v_lshlrev_b32 v150, 16, v167
    v_and_b32 v151, s27, v167
    v_sub_f32 v140, v140, v148
    v_sub_f32 v141, v141, v149
    v_sub_f32 v142, v142, v150
    v_sub_f32 v143, v143, v151
    v_cvt_pk_bf16_f32 v164, v140, v141
    v_cvt_pk_bf16_f32 v165, v142, v143
    v_lshlrev_b32 v140, 16, v164
    v_and_b32 v141, s27, v164
    v_lshlrev_b32 v142, 16, v165
    v_and_b32 v143, s27, v165
    v_mul_f32 v140, s30, v140
    v_mul_f32 v141, s30, v141
    v_mul_f32 v142, s30, v142
    v_mul_f32 v143, s30, v143
    v_exp_f32 v140, v140
    v_exp_f32 v141, v141
    v_exp_f32 v142, v142
    v_exp_f32 v143, v143
    s_nop 0
    v_cvt_pk_bf16_f32 v164, v140, v141
    v_cvt_pk_bf16_f32 v165, v142, v143
    v_lshlrev_b32 v140, 16, v164
    v_and_b32 v141, s27, v164
    v_lshlrev_b32 v142, 16, v165
    v_and_b32 v143, s27, v165
    v_fma_f32 v140, v140, s31, v188
    v_fma_f32 v141, v141, s31, v188
    v_fma_f32 v142, v142, s31, v188
    v_fma_f32 v143, v143, s31, v188
    v_cvt_pk_bf16_f32 v172, v140, v141
    v_cvt_pk_bf16_f32 v173, v142, v143
    v_cvt_pk_bf16_f32 v164, v144, v145
    v_cvt_pk_bf16_f32 v165, v146, v147
    v_cvt_pk_bf16_f32 v166, v152, v153
    v_cvt_pk_bf16_f32 v167, v154, v155
    v_lshlrev_b32 v144, 16, v164
    v_and_b32 v145, s27, v164
    v_lshlrev_b32 v146, 16, v165
    v_and_b32 v147, s27, v165
    v_lshlrev_b32 v152, 16, v166
    v_and_b32 v153, s27, v166
    v_lshlrev_b32 v154, 16, v167
    v_and_b32 v155, s27, v167
    v_sub_f32 v144, v144, v152
    v_sub_f32 v145, v145, v153
    v_sub_f32 v146, v146, v154
    v_sub_f32 v147, v147, v155
    v_cvt_pk_bf16_f32 v164, v144, v145
    v_cvt_pk_bf16_f32 v165, v146, v147
    v_lshlrev_b32 v144, 16, v164
    v_and_b32 v145, s27, v164
    v_lshlrev_b32 v146, 16, v165
    v_and_b32 v147, s27, v165
    v_mul_f32 v144, s30, v144
    v_mul_f32 v145, s30, v145
    v_mul_f32 v146, s30, v146
    v_mul_f32 v147, s30, v147
    v_exp_f32 v144, v144
    v_exp_f32 v145, v145
    v_exp_f32 v146, v146
    v_exp_f32 v147, v147
    s_nop 0
    v_cvt_pk_bf16_f32 v164, v144, v145
    v_cvt_pk_bf16_f32 v165, v146, v147
    v_lshlrev_b32 v144, 16, v164
    v_and_b32 v145, s27, v164
    v_lshlrev_b32 v146, 16, v165
    v_and_b32 v147, s27, v165
    v_fma_f32 v144, v144, s31, v188
    v_fma_f32 v145, v145, s31, v188
    v_fma_f32 v146, v146, s31, v188
    v_fma_f32 v147, v147, s31, v188
    v_cvt_pk_bf16_f32 v174, v144, v145
    v_cvt_pk_bf16_f32 v175, v146, v147
    s_cmp_eq_u32 s24, 1
    s_cbranch_scc1 L_last
L_pf5:
    ds_read_b32 v22, v23
    s_waitcnt lgkmcnt(0)
    v_readfirstlane_b32 s45, v22
    s_nop 1
    s_cmp_ge_i32 s45, s21
    s_cbranch_scc1 L_pg6
    s_sub_u32 s59, s59, 1
    s_cbranch_scc1 L_done
    s_sleep 1
    s_branch L_pf5
L_pg6:
    ds_read_b64_tr_b16 v[72:73], v14 offset:0
    ds_read_b64_tr_b16 v[74:75], v14 offset:4096
    ds_read_b64_tr_b16 v[76:77], v15 offset:0
    ds_read_b64_tr_b16 v[78:79], v15 offset:4096
    ds_read_b64_tr_b16 v[80:81], v16 offset:0
    ds_read_b64_tr_b16 v[82:83], v16 offset:4096
    ds_read_b64_tr_b16 v[84:85], v17 offset:0
    ds_read_b64_tr_b16 v[86:87], v17 offset:4096
    ds_read_b64_tr_b16 v[88:89], v18 offset:0
    ds_read_b64_tr_b16 v[90:91], v18 offset:4096
    ds_read_b64_tr_b16 v[92:93], v19 offset:0
    ds_read_b64_tr_b16 v[94:95], v19 offset:4096
    ds_read_b64_tr_b16 v[96:97], v20 offset:0
    ds_read_b64_tr_b16 v[98:99], v20 offset:4096
    ds_read_b64_tr_b16 v[100:101], v21 offset:0
    ds_read_b64_tr_b16 v[102:103], v21 offset:4096
    s_add_u32 s22, s22, 1
    v_mov_b32 v22, s22
    s_waitcnt lgkmcnt(0)
    ds_write_b32 v198, v22
    v_mfma_f32_16x16x32_bf16 v[104:107], v[172:175], v[72:75], v[104:107]
    v_mfma_f32_16x16x32_bf16 v[108:111], v[172:175], v[76:79], v[108:111]
    v_mfma_f32_16x16x32_bf16 v[112:115], v[172:175], v[80:83], v[112:115]
    v_mfma_f32_16x16x32_bf16 v[116:119], v[172:175], v[84:87], v[116:119]
    v_mfma_f32_16x16x32_bf16 v[120:123], v[172:175], v[88:91], v[120:123]
    v_mfma_f32_16x16x32_bf16 v[124:127], v[172:175], v[92:95], v[124:127]
    v_mfma_f32_16x16x32_bf16 v[128:131], v[172:175], v[96:99], v[128:131]
    v_mfma_f32_16x16x32_bf16 v[132:135], v[172:175], v[100:103], v[132:135]
    v_mfma_f32_16x16x32_bf16 v[136:139], v[172:175], v[184:187], v[136:139]
    v_xor_b32 v10, 0x4000, v10
    v_xor_b32 v11, 0x4000, v11
    v_xor_b32 v12, 0x4000, v12
    v_xor_b32 v13, 0x4000, v13
    v_xor_b32 v14, 0x4000, v14
    v_xor_b32 v15, 0x4000, v15
    v_xor_b32 v16, 0x4000, v16
    v_xor_b32 v17, 0x4000, v17
    v_xor_b32 v18, 0x4000, v18
    v_xor_b32 v19, 0x4000, v19
    v_xor_b32 v20, 0x4000, v20
    v_xor_b32 v21, 0x4000, v21
    s_add_u32 s20, s20, 2
    s_sub_u32 s24, s24, 1
    s_cmp_lg_u32 s24, 1
    s_cbranch_scc1 L_tile
    s_lshl_b32 s44, s23, 1
    s_sub_u32 s44, s44, 1
    ds_write_b128 v192, v[112:115] offset:0
    ds_write_b128 v192, v[116:119] offset:1024
    ds_write_b128 v193, v[120:123] offset:0
    ds_write_b128 v193, v[124:127] offset:1024
    ds_write_b128 v194, v[128:131] offset:0
    ds_write_b128 v194, v[132:135] offset:1024
    v_mov_b32 v22, s44
    s_waitcnt lgkmcnt(0)
    ds_write_b32 v198, v22 offset:1024
L_pd7:
    ds_read_b32 v22, v199
    s_waitcnt lgkmcnt(0)
    s_sub_u32 s59, s59, 1
    s_cbranch_scc1 L_done
    v_cmp_gt_u32 vcc, s44, v22
    s_cbranch_vccnz L_pd7
    ds_read_b128 v[72:75], v195 offset:0
    ds_read_b128 v[76:79], v195 offset:1024
    ds_read_b128 v[80:83], v195 offset:2048
    ds_read_b128 v[84:87], v195 offset:3072
    ds_read_b128 v[88:91], v195 offset:4096
    ds_read_b128 v[92:95], v195 offset:5120
    s_waitcnt lgkmcnt(0)
    v_add_f32 v104, v104, v72
    v_add_f32 v105, v105, v73
    v_add_f32 v106, v106, v74
    v_add_f32 v107, v107, v75
    v_add_f32 v108, v108, v76
    v_add_f32 v109, v109, v77
    v_add_f32 v110, v110, v78
    v_add_f32 v111, v111, v79
    v_add_f32 v104, v104, v80
    v_add_f32 v105, v105, v81
    v_add_f32 v106, v106, v82
    v_add_f32 v107, v107, v83
    v_add_f32 v108, v108, v84
    v_add_f32 v109, v109, v85
    v_add_f32 v110, v110, v86
    v_add_f32 v111, v111, v87
    v_add_f32 v104, v104, v88
    v_add_f32 v105, v105, v89
    v_add_f32 v106, v106, v90
    v_add_f32 v107, v107, v91
    v_add_f32 v108, v108, v92
    v_add_f32 v109, v109, v93
    v_add_f32 v110, v110, v94
    v_add_f32 v111, v111, v95
    s_branch L_tile
L_last:
    v_lshlrev_b32 v3, 4, v0
    v_add_u32 v146, s26, v3
    v_mfma_f32_16x16x32_bf16 v[136:139], v[172:175], v[184:187], v[136:139]
    ds_write_b128 v146, v[172:175] offset:16384
    s_add_u32 s45, s25, 1
    s_and_b32 s45, s45, 3
    s_lshl_b32 s45, s45, 15
    v_add_u32 v148, s45, v3
    s_sub_u32 s45, s45, s26
    v_add_u32 v140, s45, v14
    v_add_u32 v141, s45, v15
    s_add_u32 s45, s25, 2
    s_and_b32 s45, s45, 3
    s_lshl_b32 s45, s45, 15
    v_add_u32 v149, s45, v3
    s_sub_u32 s45, s45, s26
    v_add_u32 v142, s45, v14
    v_add_u32 v143, s45, v15
    s_add_u32 s45, s25, 3
    s_and_b32 s45, s45, 3
    s_lshl_b32 s45, s45, 15
    v_add_u32 v150, s45, v3
    s_sub_u32 s45, s45, s26
    v_add_u32 v144, s45, v14
    v_add_u32 v145, s45, v15
    s_lshl_b32 s44, s23, 1
    s_nop 3
    ds_write_b128 v196, v[136:139]
    v_mov_b32 v22, s44
    s_waitcnt lgkmcnt(0)
    ds_write_b32 v198, v22 offset:1024
L_pd8:
    ds_read_b32 v22, v199
    s_waitcnt lgkmcnt(0)
    s_sub_u32 s59, s59, 1
    s_cbranch_scc1 L_done
    v_cmp_gt_u32 vcc, s44, v22
    s_cbranch_vccnz L_pd8
    ds_read_b128 v[88:91], v148 offset:16384
    ds_read_b128 v[92:95], v149 offset:16384
    ds_read_b128 v[96:99], v150 offset:16384
    ds_read_b128 v[72:75], v197 offset:0
    ds_read_b128 v[76:79], v197 offset:1024
    ds_read_b128 v[80:83], v197 offset:2048
    ds_read_b128 v[84:87], v197 offset:3072
    ds_read_b64 v[176:177], v178
    v_lshlrev_b32 v3, 8, v1
    v_lshl_add_u32 v3, v2, 3, v3
    s_lshl_b32 s44, s25, 6
    v_add_u32 v3, s44, v3
    s_waitcnt lgkmcnt(0)
    v_add_f32 v72, v72, v76
    v_add_f32 v73, v73, v77
    v_add_f32 v74, v74, v78
    v_add_f32 v75, v75, v79
    v_add_f32 v72, v72, v80
    v_add_f32 v73, v73, v81
    v_add_f32 v74, v74, v82
    v_add_f32 v75, v75, v83
    v_add_f32 v72, v72, v84
    v_add_f32 v73, v73, v85
    v_add_f32 v74, v74, v86
    v_add_f32 v75, v75, v87
    v_cvt_pk_bf16_f32 v164, v72, v73
    v_cvt_pk_bf16_f32 v165, v74, v75
    s_nop 1
    v_mfma_f32_16x16x16_bf16 v[136:139], v[164:165], v[176:177], 0
    s_nop 7
    s_nop 1
    v_cvt_pk_bf16_f32 v190, v136, v136
    v_and_b32 v190, s27, v190
    v_add_f32 v190, v190, v188
    v_cvt_pk_bf16_f32 v190, v190, v190
    v_and_b32 v190, s27, v190
    v_rcp_f32 v191, v190
L_pf9:
    ds_read_b32 v22, v23
    s_waitcnt lgkmcnt(0)
    v_readfirstlane_b32 s45, v22
    s_nop 1
    s_cmp_ge_i32 s45, s21
    s_cbranch_scc1 L_pg10
    s_sub_u32 s59, s59, 1
    s_cbranch_scc1 L_done
    s_sleep 1
    s_branch L_pf9
L_pg10:
    ds_read_b64_tr_b16 v[40:41], v14 offset:0
    ds_read_b64_tr_b16 v[42:43], v14 offset:4096
    ds_read_b64_tr_b16 v[44:45], v15 offset:0
    ds_read_b64_tr_b16 v[46:47], v15 offset:4096
    ds_read_b64_tr_b16 v[48:49], v140 offset:0
    ds_read_b64_tr_b16 v[50:51], v140 offset:4096
    ds_read_b64_tr_b16 v[52:53], v141 offset:0
    ds_read_b64_tr_b16 v[54:55], v141 offset:4096
    ds_read_b64_tr_b16 v[56:57], v142 offset:0
    ds_read_b64_tr_b16 v[58:59], v142 offset:4096
    ds_read_b64_tr_b16 v[60:61], v143 offset:0
    ds_read_b64_tr_b16 v[62:63], v143 offset:4096
    ds_read_b64_tr_b16 v[64:65], v144 offset:0
    ds_read_b64_tr_b16 v[66:67], v144 offset:4096
    ds_read_b64_tr_b16 v[68:69], v145 offset:0
    ds_read_b64_tr_b16 v[70:71], v145 offset:4096
    s_add_u32 s22, s22, 1
    v_mov_b32 v22, s22
    s_waitcnt lgkmcnt(0)
    ds_write_b32 v198, v22
    v_mfma_f32_16x16x32_bf16 v[104:107], v[172:175], v[40:43], v[104:107]
    v_mfma_f32_16x16x32_bf16 v[108:111], v[172:175], v[44:47], v[108:111]
    v_mfma_f32_16x16x32_bf16 v[104:107], v[88:91], v[48:51], v[104:107]
    v_mfma_f32_16x16x32_bf16 v[108:111], v[88:91], v[52:55], v[108:111]
    v_mfma_f32_16x16x32_bf16 v[104:107], v[92:95], v[56:59], v[104:107]
    v_mfma_f32_16x16x32_bf16 v[108:111], v[92:95], v[60:63], v[108:111]
    v_mfma_f32_16x16x32_bf16 v[104:107], v[96:99], v[64:67], v[104:107]
    v_mfma_f32_16x16x32_bf16 v[108:111], v[96:99], v[68:71], v[108:111]
    v_xor_b32 v10, 0x4000, v10
    v_xor_b32 v11, 0x4000, v11
    v_xor_b32 v12, 0x4000, v12
    v_xor_b32 v13, 0x4000, v13
    v_xor_b32 v14, 0x4000, v14
    v_xor_b32 v15, 0x4000, v15
    v_xor_b32 v16, 0x4000, v16
    v_xor_b32 v17, 0x4000, v17
    v_xor_b32 v18, 0x4000, v18
    v_xor_b32 v19, 0x4000, v19
    v_xor_b32 v20, 0x4000, v20
    v_xor_b32 v21, 0x4000, v21
    s_add_u32 s20, s20, 2
    v_cvt_pk_bf16_f32 v156, v104, v105
    v_cvt_pk_bf16_f32 v157, v106, v107
    v_cvt_pk_bf16_f32 v158, v108, v109
    v_cvt_pk_bf16_f32 v159, v110, v111
    s_nop 1
    v_mfma_f32_16x16x16_bf16 v[104:107], v[156:157], v[176:177], 0
    v_mfma_f32_16x16x16_bf16 v[108:111], v[158:159], v[176:177], 0
    s_nop 7
    s_nop 1
    v_cvt_pk_bf16_f32 v158, v104, v105
    v_cvt_pk_bf16_f32 v159, v106, v107
    v_lshlrev_b32 v104, 16, v158
    v_and_b32 v105, s27, v158
    v_lshlrev_b32 v106, 16, v159
    v_and_b32 v107, s27, v159
    v_mul_f32 v160, v104, v191
    v_mul_f32 v161, v105, v191
    v_mul_f32 v162, v106, v191
    v_mul_f32 v163, v107, v191
    v_fma_f32 v164, -v160, v190, v104
    v_fma_f32 v165, -v161, v190, v105
    v_fma_f32 v166, -v162, v190, v106
    v_fma_f32 v167, -v163, v190, v107
    v_fma_f32 v160, v164, v191, v160
    v_fma_f32 v161, v165, v191, v161
    v_fma_f32 v162, v166, v191, v162
    v_fma_f32 v163, v167, v191, v163
    v_div_fixup_f32 v160, v160, v190, v104
    v_div_fixup_f32 v161, v161, v190, v105
    v_div_fixup_f32 v162, v162, v190, v106
    v_div_fixup_f32 v163, v163, v190, v107
    v_cvt_pk_bf16_f32 v104, v160, v161
    v_cvt_pk_bf16_f32 v105, v162, v163
    buffer_store_dwordx2 v[104:105], v3, s[12:15], 0 offen offset:0
    v_cvt_pk_bf16_f32 v158, v108, v109
    v_cvt_pk_bf16_f32 v159, v110, v111
    v_lshlrev_b32 v108, 16, v158
    v_and_b32 v109, s27, v158
    v_lshlrev_b32 v110, 16, v159
    v_and_b32 v111, s27, v159
    v_mul_f32 v160, v108, v191
    v_mul_f32 v161, v109, v191
    v_mul_f32 v162, v110, v191
    v_mul_f32 v163, v111, v191
    v_fma_f32 v164, -v160, v190, v108
    v_fma_f32 v165, -v161, v190, v109
    v_fma_f32 v166, -v162, v190, v110
    v_fma_f32 v167, -v163, v190, v111
    v_fma_f32 v160, v164, v191, v160
    v_fma_f32 v161, v165, v191, v161
    v_fma_f32 v162, v166, v191, v162
    v_fma_f32 v163, v167, v191, v163
    v_div_fixup_f32 v160, v160, v190, v108
    v_div_fixup_f32 v161, v161, v190, v109
    v_div_fixup_f32 v162, v162, v190, v110
    v_div_fixup_f32 v163, v163, v190, v111
    v_cvt_pk_bf16_f32 v108, v160, v161
    v_cvt_pk_bf16_f32 v109, v162, v163
    buffer_store_dwordx2 v[108:109], v3, s[12:15], 0 offen offset:32
    s_cmp_eq_u32 s23, 2
    s_cbranch_scc1 L_fin
    s_mov_b32 s23, 2
    s_add_u32 s12, s12, 2048
    s_addc_u32 s13, s13, 0
    v_add_u32 v178, 512, v178
    s_branch L_bh
L_fin:
L_done:
    s_endpgm
.section .rodata,"a"
.p2align 6
.amdhsa_kernel standalone__linear_kernel_rfa__sampling_kernel
  .amdhsa_next_free_vgpr 200
  .amdhsa_next_free_sgpr 96
  .amdhsa_accum_offset 200
  .amdhsa_group_segment_fixed_size 0
  .amdhsa_kernarg_size 56
  .amdhsa_user_sgpr_count 2
  .amdhsa_user_sgpr_kernarg_segment_ptr 1
  .amdhsa_system_sgpr_workgroup_id_x 1
  .amdhsa_float_denorm_mode_32 3
.end_amdhsa_kernel
```
